```python
import torch

def _softmax(x, axis=-1):
    return torch.softmax(x, dim=axis)
def _gelu(x):
    return torch.nn.functional.gelu(x, approximate="tanh")
def _silu(x):
    return torch.nn.functional.silu(x)
def _sigmoid(x):
    return torch.sigmoid(x)
def _layernorm(x, axis=-1, eps=1e-5):
    m = x.mean(dim=axis, keepdim=True)
    v = x.var(dim=axis, keepdim=True, unbiased=False)
    return (x - m) / torch.sqrt(v + eps)
def _scatter_add(tgt, idx, src, axis=0):
    return tgt.clone().index_add_(axis, idx, src)
def _segment_sum(src, seg, n):
    out = torch.zeros((n,) + src.shape[1:], dtype=src.dtype)
    return out.index_add_(0, seg, src)
def _pad(x, pw):
    flat = tuple(v for pair in reversed(pw) for v in pair)
    return torch.nn.functional.pad(x, flat)

kernel_name = 'standalone__mha_block_cached__near_ridge'

def setup_inputs():

    _w = (lambda a: (lambda t: t.to(torch.bfloat16) if t.is_floating_point() else t)(torch.as_tensor(a)))
    B, Sq, D = 8, 160, 1024
    H, Sk, Dh = 32, 512, 128
    return {
        "x": _w((lambda *s: torch.randn(*s, dtype=torch.bfloat16) * 0.8)(B, Sq, D)),
        "k_cache": _w((lambda *s: torch.randn(*s, dtype=torch.bfloat16) * 0.8)(B, H, Sk, Dh)),
        "v_cache": _w((lambda *s: torch.randn(*s, dtype=torch.bfloat16) * 0.05)(B, H, Sk, Dh)),
        "wq": _w((lambda *s: torch.randn(*s, dtype=torch.bfloat16) * 0.8)(D, H * Dh) * (D ** -0.5)),
        "wo": _w((lambda *s: torch.randn(*s, dtype=torch.bfloat16) * 0.05)(H * Dh, D) * ((H * Dh) ** -0.5)),
    }

def reference(x, k_cache, v_cache, wq, wo):
    B, Sq, D = x.shape
    H, Dh = 32, 128
    q = (lambda x, *d: x.permute(*d))((x @ wq).reshape(B, Sq, H, Dh), 0, 2, 1, 3)
    scores = torch.einsum("bhqd,bhkd->bhqk", q, k_cache) * (Dh ** -0.5)
    p = _softmax(scores, axis=-1)
    o = torch.einsum("bhqk,bhkd->bhqd", p, v_cache)
    return (lambda x, *d: x.permute(*d))(o, 0, 2, 1, 3).reshape(B, Sq, H * Dh) @ wo
```

```asm
; @launch grid=(256,1,1) block=(256,1,1) lds=163840
.amdgcn_target "amdgcn-amd-amdhsa--gfx950"
.text
.globl standalone__mha_block_cached__near_ridge_kernel
.p2align 8
.type standalone__mha_block_cached__near_ridge_kernel,@function
standalone__mha_block_cached__near_ridge_kernel:
    s_cmp_ge_u32 s2, 256
    s_cbranch_scc1 L_end
    s_load_dwordx4 s[4:7], s[0:1], 0
    s_load_dwordx4 s[8:11], s[0:1], 16
    s_load_dwordx4 s[68:71], s[0:1], 40
    s_load_dwordx2 s[76:77], s[0:1], 32
    s_load_dwordx2 s[20:21], s[0:1], 56
    s_memrealtime s[64:65]
    v_and_b32 v1, 63, v0
    v_lshrrev_b32 v21, 6, v0
    s_and_b32 s29, s2, 1
    s_lshl_b32 s29, s29, 2
    s_lshr_b32 s41, s2, 3
    s_and_b32 s60, s41, 3
    s_add_u32 s29, s29, s60
    v_readfirstlane_b32 s28, v21
    s_lshr_b32 s62, s2, 1
    s_and_b32 s62, s62, 3
    s_lshl_b32 s30, s62, 3
    s_lshr_b32 s61, s41, 2
    s_add_u32 s52, s60, s61
    s_and_b32 s52, s52, 3
    s_add_u32 s30, s30, s61
    s_mov_b32 s58, 1750279184
    s_mov_b32 s59, 4275809431
    s_mov_b32 s35, 42
    s_cmp_eq_u32 s52, 1
    s_cselect_b32 s58, 2520994320, s58
    s_cselect_b32 s59, 4274772615, s59
    s_cselect_b32 s35, 84, s35
    s_cmp_eq_u32 s52, 2
    s_cselect_b32 s58, 1967534368, s58
    s_cselect_b32 s59, 4258183562, s59
    s_cselect_b32 s35, 140, s35
    s_cmp_eq_u32 s52, 3
    s_cselect_b32 s58, 1702105888, s58
    s_cselect_b32 s59, 3992758712, s59
    s_cselect_b32 s35, 274, s35
    s_xor_b32 s42, s2, s62
    s_bitcmp1_b32 s42, 0
    s_cselect_b32 s42, 0x88888888, 0
    s_xor_b32 s58, s58, s42
    s_xor_b32 s59, s59, s42
    s_lshl_b32 s44, s28, 12
    s_lshl_b32 s45, s28, 10
    s_and_b32 s56, s28, 1
    s_lshr_b32 s57, s28, 1
    s_getpc_b64 s[92:93]
L_pc:
    s_lshr_b32 s39, s2, 3
    s_lshl_b32 s39, s39, 2
    s_add_u32 s39, s39, s28
    s_lshl_b32 s39, s39, 7
    s_min_u32 s39, s39, L_last-L_pc
    s_add_u32 s92, s92, s39
    s_addc_u32 s93, s93, 0
    v_mov_b32 v24, s92
    v_mov_b32 v25, s93
    global_load_dword a228, v[24:25], off
    v_lshrrev_b32 v21, 4, v1
    v_and_b32 v22, 7, v1
    v_xor_b32 v22, v22, v21
    v_lshlrev_b32 v22, 4, v22
    v_lshrrev_b32 v23, 3, v1
    v_lshlrev_b32 v23, 11, v23
    v_add_u32 v22, v22, v23
    v_xor_b32 v23, 64, v22
    s_lshl_b32 s41, s28, 16
    s_add_u32 s42, s41, 0
    v_add_u32 v8, s42, v22
    s_add_u32 s42, s41, 15360
    v_add_u32 v9, s42, v23
    s_add_u32 s42, s41, 30720
    v_add_u32 v10, s42, v22
    s_add_u32 s42, s41, 46080
    v_add_u32 v11, s42, v23
    s_lshl_b32 s41, s56, 6
    v_xor_b32 v12, s41, v22
    s_lshl_b32 s41, s28, 14
    s_add_u32 s41, s41, 262144
    v_add_u32 v12, s41, v12
    v_lshlrev_b32 v22, 1, v21
    v_and_b32 v23, 15, v1
    v_xor_b32 v22, v22, v23
    v_lshlrev_b32 v22, 4, v22
    v_lshlrev_b32 v23, 13, v21
    v_add_u32 v23, v23, v22
    v_xor_b32 v20, 128, v23
    s_lshl_b32 s41, s28, 17
    s_add_u32 s42, s41, 0
    v_add_u32 v13, s42, v23
    s_add_u32 s42, s41, 31744
    v_add_u32 v14, s42, v23
    s_add_u32 s42, s41, 63488
    v_add_u32 v15, s42, v20
    s_add_u32 s42, s41, 95232
    v_add_u32 v16, s42, v20
    s_add_u32 s40, s45, 16384
    s_lshl_b32 s41, s29, 5
    s_add_u32 s41, s41, s30
    s_lshl_b32 s41, s41, 17
    s_lshl_b32 s42, s30, 8
    s_mul_i32 s43, s29, 327680
    s_waitcnt lgkmcnt(0)
    s_add_u32 s12, s6, s41
    s_addc_u32 s13, s7, 0
    s_add_u32 s16, s8, s41
    s_addc_u32 s17, s9, 0
    s_add_u32 s8, s10, s42
    s_addc_u32 s9, s11, 0
    s_sub_u32 s10, 8388608, s42
    s_mov_b32 s11, 0x20000
    s_add_u32 s4, s4, s43
    s_addc_u32 s5, s5, 0
    s_mov_b32 s6, 327680
    s_mov_b32 s7, 0x20000
    s_and_b32 s41, s58, 15
    s_add_u32 m0, s44, 147456
    s_lshl_b32 s37, s41, 19
    buffer_load_dwordx4 v13, s[8:11], s37 offen offset:0 lds
    buffer_load_dwordx4 v14, s[8:11], s37 offen offset:1024 lds
    buffer_load_dwordx4 v15, s[8:11], s37 offen offset:2048 lds
    buffer_load_dwordx4 v16, s[8:11], s37 offen offset:3072 lds
    s_add_u32 m0, s44, 126976
    s_lshl_b32 s36, s41, 7
    buffer_load_dwordx4 v8, s[4:7], s36 offen offset:0  lds
    buffer_load_dwordx4 v9, s[4:7], s36 offen offset:1024  lds
    buffer_load_dwordx4 v10, s[4:7], s36 offen offset:2048  lds
    buffer_load_dwordx4 v11, s[4:7], s36 offen offset:3072  lds
    s_add_u32 m0, s40, 126976
    s_lshr_b64 s[58:59], s[58:59], 4
    buffer_load_dwordx4 v12, s[4:7], s36 offen  lds
    s_mov_b32 s32, 126976
    s_mov_b32 s31, 0
    s_mov_b32 s33, 90112
    s_mov_b32 s63, 0
    v_and_b32 v26, 15, v1
    v_lshrrev_b32 v27, 1, v26
    v_xor_b32 v27, v27, v21
    v_lshlrev_b32 v27, 4, v27
    v_lshlrev_b32 v25, 7, v26
    v_add_u32 v27, v27, v25
    s_mul_i32 s41, s56, 10240
    s_add_u32 s41, s41, s32
    v_xor_b32 v2, 0, v27
    v_add_u32 v2, s41, v2
    v_xor_b32 v3, 64, v27
    v_add_u32 v3, s41, v3
    v_lshrrev_b32 v30, 2, v1
    v_and_b32 v31, 7, v30
    v_and_b32 v26, 3, v30
    s_lshl_b32 s41, s57, 2
    v_xor_b32 v27, s41, v31
    v_lshlrev_b32 v27, 5, v27
    v_lshlrev_b32 v25, 3, v21
    v_add_u32 v28, v25, v26
    v_lshlrev_b32 v28, 8, v28
    v_and_b32 v29, 3, v1
    v_lshlrev_b32 v29, 3, v29
    v_add3_u32 v28, v28, v27, v29
    s_add_u32 s41, s32, 20480
    v_xor_b32 v4, 0, v28
    v_add_u32 v4, s41, v4
    v_xor_b32 v5, 32, v28
    v_add_u32 v5, s41, v5
    v_xor_b32 v6, 64, v28
    v_add_u32 v6, s41, v6
    v_xor_b32 v7, 96, v28
    v_add_u32 v7, s41, v7
    v_lshlrev_b32 v23, 8, v21
    v_add_u32 v22, v22, v23
    s_lshl_b32 s41, s56, 7
    v_xor_b32 v17, s41, v22
    v_add_u32 v17, s45, v17
    s_mul_i32 s66, s2, 0x9E3779B1
    s_lshr_b32 s66, s66, 27
    s_lshl_b32 s66, s66, 12
    s_mov_b32 s47, s45
    s_mov_b32 s48, 0
    s_mov_b32 s55, s66
    s_mov_b32 s14, 131072
    s_mov_b32 s15, 0x20000
    s_mov_b32 s18, 131072
    s_mov_b32 s19, 0x20000
    s_mov_b32 s22, 28311552
    s_mov_b32 s23, 0x20000
    s_mov_b32 s24, s70
    s_mov_b32 s25, s71
    s_mov_b32 s26, 256
    s_mov_b32 s27, 0x20000
    s_add_u32 s68, s68, s43
    s_addc_u32 s69, s69, 0
    s_mov_b32 s70, 327680
    s_mov_b32 s71, 0x20000
    s_lshl_b32 s41, s29, 2
    s_add_u32 s41, s41, s62
    s_mul_i32 s41, s41, 327680
    s_add_u32 s72, s20, s41
    s_addc_u32 s73, s21, 0
    s_mov_b32 s74, 327680
    s_mov_b32 s75, 0x20000
    s_lshl_b32 s41, s62, 13
    s_add_u32 s41, s41, s61
    s_lshl_b32 s41, s41, 8
    s_add_u32 s76, s76, s41
    s_addc_u32 s77, s77, 0
    s_sub_u32 s78, 8388608, s41
    s_mov_b32 s79, 0x20000
    v_mov_b32 v64, 0
    v_mov_b32 v65, 0
    v_mov_b32 v66, 0
    v_mov_b32 v67, 0
    v_mov_b32 v68, 0
    v_mov_b32 v69, 0
    v_mov_b32 v70, 0
    v_mov_b32 v71, 0
    v_mov_b32 v72, 0
    v_mov_b32 v73, 0
    v_mov_b32 v74, 0
    v_mov_b32 v75, 0
    v_mov_b32 v76, 0
    v_mov_b32 v77, 0
    v_mov_b32 v78, 0
    v_mov_b32 v79, 0
    v_mov_b32 v80, 0
    v_mov_b32 v81, 0
    v_mov_b32 v82, 0
    v_mov_b32 v83, 0
    v_mov_b32 v84, 0
    v_mov_b32 v85, 0
    v_mov_b32 v86, 0
    v_mov_b32 v87, 0
    v_mov_b32 v88, 0
    v_mov_b32 v89, 0
    v_mov_b32 v90, 0
    v_mov_b32 v91, 0
    v_mov_b32 v92, 0
    v_mov_b32 v93, 0
    v_mov_b32 v94, 0
    v_mov_b32 v95, 0
    v_mov_b32 v96, 0
    v_mov_b32 v97, 0
    v_mov_b32 v98, 0
    v_mov_b32 v99, 0
    v_mov_b32 v100, 0
    v_mov_b32 v101, 0
    v_mov_b32 v102, 0
    v_mov_b32 v103, 0
    s_and_b32 s41, s58, 15
    s_add_u32 m0, s44, 73728
    s_lshl_b32 s37, s41, 19
    buffer_load_dwordx4 v13, s[8:11], s37 offen offset:0 lds
    buffer_load_dwordx4 v14, s[8:11], s37 offen offset:1024 lds
    buffer_load_dwordx4 v15, s[8:11], s37 offen offset:2048 lds
    buffer_load_dwordx4 v16, s[8:11], s37 offen offset:3072 lds
    s_add_u32 m0, s44, 53248
    s_lshl_b32 s36, s41, 7
    buffer_load_dwordx4 v8, s[4:7], s36 offen offset:0  lds
    buffer_load_dwordx4 v9, s[4:7], s36 offen offset:1024  lds
    buffer_load_dwordx4 v10, s[4:7], s36 offen offset:2048  lds
    buffer_load_dwordx4 v11, s[4:7], s36 offen offset:3072  lds
    s_add_u32 m0, s40, 53248
    s_lshr_b64 s[58:59], s[58:59], 4
    buffer_load_dwordx4 v12, s[4:7], s36 offen  lds
    v_mov_b32 v236, 0
    v_mov_b32 v237, 0
    v_mov_b32 v240, 0
    v_mov_b32 v255, 0
    v_mov_b32 v248, 0
    v_mov_b32 v249, 0
    v_mov_b32 v250, 0
    v_mov_b32 v251, 0
    v_mov_b32 v252, 0
    v_mov_b32 v253, 0
    s_or_b32 s41, s2, s28
    s_cmp_lg_u32 s41, 0
    s_cbranch_scc1 L_nonon
    s_or_b32 s64, s64, 1
    v_mov_b32 v24, s64
    v_mov_b32 v25, s65
    buffer_store_dwordx2 v[24:25], v240, s[24:27], 0 offen sc0 sc1
L_nonon:
    s_waitcnt vmcnt(9)
    s_barrier
    ds_read_b64_tr_b16 a[80:81], v4 offset:0
    ds_read_b64_tr_b16 a[82:83], v4 offset:1024
    ds_read_b64_tr_b16 a[96:97], v4 offset:8192
    ds_read_b64_tr_b16 a[98:99], v4 offset:9216
    ds_read_b128 a[132:135], v3 offset:0
    ds_read_b128 a[112:115], v2 offset:0
    ds_read_b128 a[116:119], v2 offset:2048
    ds_read_b128 a[136:139], v3 offset:2048
    ds_read_b128 a[140:143], v3 offset:4096
    ds_read_b128 a[120:123], v2 offset:4096
    ds_read_b128 a[124:127], v2 offset:6144
    ds_read_b128 a[144:147], v3 offset:6144
    ds_read_b128 a[148:151], v3 offset:8192
    ds_read_b128 a[128:131], v2 offset:8192
    ds_read_b64_tr_b16 a[84:85], v5 offset:0
    ds_read_b64_tr_b16 a[86:87], v5 offset:1024
    ds_read_b64_tr_b16 a[100:101], v5 offset:8192
    ds_read_b64_tr_b16 a[102:103], v5 offset:9216
    s_and_b32 s41, s58, 15
    s_lshl_b32 s37, s41, 19
    s_add_u32 s38, s33, s44
    s_add_u32 m0, s38, 20480
    s_add_u32 s42, s32, 36864
    s_cmp_ge_u32 s42, 163840
    s_cselect_b32 s42, 53248, s42
    s_sub_u32 s34, s42, s32
    s_lshl_b32 s36, s41, 7
    s_waitcnt lgkmcnt(12)
    v_mfma_f32_16x16x32_bf16 v[24:27], a[80:83], a[112:115], 0
    buffer_load_dwordx4 v13, s[8:11], s37 offen offset:0 lds
    v_mfma_f32_16x16x32_bf16 v[24:27], a[96:99], a[132:135], v[24:27]
    ds_read_b64_tr_b16 a[88:89], v6 offset:0
    s_waitcnt lgkmcnt(11)
    v_mfma_f32_16x16x32_bf16 v[28:31], a[96:99], a[136:139], 0
    buffer_load_dwordx4 v14, s[8:11], s37 offen offset:1024 lds
    v_mfma_f32_16x16x32_bf16 v[28:31], a[80:83], a[116:119], v[28:31]
    ds_read_b64_tr_b16 a[90:91], v6 offset:1024
    s_waitcnt lgkmcnt(10)
    v_mfma_f32_16x16x32_bf16 v[32:35], a[80:83], a[120:123], 0
    buffer_load_dwordx4 v15, s[8:11], s37 offen offset:2048 lds
    v_mfma_f32_16x16x32_bf16 v[32:35], a[96:99], a[140:143], v[32:35]
    ds_read_b64_tr_b16 a[104:105], v6 offset:8192
    s_waitcnt lgkmcnt(9)
    v_mfma_f32_16x16x32_bf16 v[36:39], a[96:99], a[144:147], 0
    buffer_load_dwordx4 v16, s[8:11], s37 offen offset:3072 lds
    v_mfma_f32_16x16x32_bf16 v[36:39], a[80:83], a[124:127], v[36:39]
    ds_read_b64_tr_b16 a[106:107], v6 offset:9216
    s_waitcnt lgkmcnt(8)
    v_mfma_f32_16x16x32_bf16 v[40:43], a[80:83], a[128:131], 0
    s_mov_b32 m0, s38
    s_lshr_b64 s[58:59], s[58:59], 4
    s_add_u32 s39, s33, s40
    s_waitcnt lgkmcnt(4)
    v_mfma_f32_16x16x32_bf16 v[40:43], a[96:99], a[148:151], v[40:43]
    ds_read_b64_tr_b16 a[92:93], v7 offset:0
    s_mov_b32 s33, s32
    v_mfma_f32_16x16x32_bf16 v[60:63], a[100:103], a[148:151], 0
    buffer_load_dwordx4 v8, s[4:7], s36 offen offset:0  lds
    v_mfma_f32_16x16x32_bf16 v[60:63], a[84:87], a[128:131], v[60:63]
    ds_read_b64_tr_b16 a[94:95], v7 offset:1024
    s_mov_b32 s32, s42
    v_mfma_f32_16x16x32_bf16 v[56:59], a[84:87], a[124:127], 0
    buffer_load_dwordx4 v9, s[4:7], s36 offen offset:1024  lds
    v_mfma_f32_16x16x32_bf16 v[56:59], a[100:103], a[144:147], v[56:59]
    ds_read_b64_tr_b16 a[108:109], v7 offset:8192
    s_add_u32 s31, s31, 1
    v_mfma_f32_16x16x32_bf16 v[52:55], a[100:103], a[140:143], 0
    buffer_load_dwordx4 v10, s[4:7], s36 offen offset:2048  lds
    v_mfma_f32_16x16x32_bf16 v[52:55], a[84:87], a[120:123], v[52:55]
    ds_read_b64_tr_b16 a[110:111], v7 offset:9216
    s_cmp_lt_u32 s31, 14
    v_mfma_f32_16x16x32_bf16 v[48:51], a[84:87], a[116:119], 0
    buffer_load_dwordx4 v11, s[4:7], s36 offen offset:3072  lds
    v_mfma_f32_16x16x32_bf16 v[48:51], a[100:103], a[136:139], v[48:51]
    s_cselect_b64 vcc, -1, 0
    s_mov_b32 m0, s39
    s_bitcmp1_b32 s35, s31
    v_mfma_f32_16x16x32_bf16 v[44:47], a[100:103], a[132:135], 0
    buffer_load_dwordx4 v12, s[4:7], s36 offen  lds
    v_mfma_f32_16x16x32_bf16 v[44:47], a[84:87], a[112:115], v[44:47]
    v_add_u32 v4, s34, v4
    v_add_u32 v5, s34, v5
    v_add_u32 v2, s34, v2
    v_add_u32 v3, s34, v3
    v_add_u32 v6, s34, v6
    v_add_u32 v7, s34, v7
    s_branch L_p1end
.p2align 3
L_p1:
    s_barrier
    v_mfma_f32_16x16x32_bf16 v[64:67], a[88:91], a[112:115], v[64:67]
    ds_read_b64_tr_b16 a[80:81], v4 offset:0
    s_and_b32 s41, s58, 15
    v_mfma_f32_16x16x32_bf16 v[64:67], a[104:107], a[132:135], v[64:67]
    ds_read_b64_tr_b16 a[82:83], v4 offset:1024
    s_lshl_b32 s37, s41, 19
    v_mfma_f32_16x16x32_bf16 v[68:71], a[104:107], a[136:139], v[68:71]
    ds_read_b64_tr_b16 a[96:97], v4 offset:8192
    s_add_u32 s38, s33, s44
    v_mfma_f32_16x16x32_bf16 v[68:71], a[88:91], a[116:119], v[68:71]
    ds_read_b64_tr_b16 a[98:99], v4 offset:9216
    s_add_u32 m0, s38, 20480
    v_mfma_f32_16x16x32_bf16 v[72:75], a[88:91], a[120:123], v[72:75]
    buffer_load_dwordx4 v13, s[8:11], s37 offen offset:0 lds
    v_mfma_f32_16x16x32_bf16 v[72:75], a[104:107], a[140:143], v[72:75]
    ds_read_b64_tr_b16 a[84:85], v5 offset:0
    s_add_u32 s42, s32, 36864
    v_mfma_f32_16x16x32_bf16 v[76:79], a[104:107], a[144:147], v[76:79]
    ds_read_b64_tr_b16 a[86:87], v5 offset:1024
    s_cmp_ge_u32 s42, 163840
    v_mfma_f32_16x16x32_bf16 v[76:79], a[88:91], a[124:127], v[76:79]
    ds_read_b64_tr_b16 a[100:101], v5 offset:8192
    s_cselect_b32 s42, 53248, s42
    v_mfma_f32_16x16x32_bf16 v[80:83], a[88:91], a[128:131], v[80:83]
    ds_read_b64_tr_b16 a[102:103], v5 offset:9216
    s_sub_u32 s34, s42, s32
    v_mfma_f32_16x16x32_bf16 v[80:83], a[104:107], a[148:151], v[80:83]
    buffer_load_dwordx4 v14, s[8:11], s37 offen offset:1024 lds
    v_mfma_f32_16x16x32_bf16 v[84:87], a[108:111], a[132:135], v[84:87]
    ds_read_b128 a[132:135], v3 offset:0
    s_lshl_b32 s36, s41, 7
    v_mfma_f32_16x16x32_bf16 v[84:87], a[92:95], a[112:115], v[84:87]
    ds_read_b128 a[112:115], v2 offset:0
    v_mfma_f32_16x16x32_bf16 v[88:91], a[92:95], a[116:119], v[88:91]
    ds_read_b128 a[116:119], v2 offset:2048
    v_mfma_f32_16x16x32_bf16 v[88:91], a[108:111], a[136:139], v[88:91]
    ds_read_b128 a[136:139], v3 offset:2048
    v_mfma_f32_16x16x32_bf16 v[92:95], a[108:111], a[140:143], v[92:95]
    buffer_load_dwordx4 v15, s[8:11], s37 offen offset:2048 lds
    v_mfma_f32_16x16x32_bf16 v[92:95], a[92:95], a[120:123], v[92:95]
    ds_read_b128 a[140:143], v3 offset:4096
    ds_read_b128 a[120:123], v2 offset:4096
    v_mfma_f32_16x16x32_bf16 v[96:99], a[92:95], a[124:127], v[96:99]
    ds_read_b128 a[124:127], v2 offset:6144
    v_mfma_f32_16x16x32_bf16 v[96:99], a[108:111], a[144:147], v[96:99]
    ds_read_b128 a[144:147], v3 offset:6144
    v_mfma_f32_16x16x32_bf16 v[100:103], a[108:111], a[148:151], v[100:103]
    ds_read_b128 a[148:151], v3 offset:8192
    v_mfma_f32_16x16x32_bf16 v[100:103], a[92:95], a[128:131], v[100:103]
    ds_read_b128 a[128:131], v2 offset:8192
    s_waitcnt lgkmcnt(8)
    v_mfma_f32_16x16x32_bf16 v[24:27], a[80:83], a[112:115], v[24:27]
    buffer_load_dwordx4 v16, s[8:11], s37 offen offset:3072 lds
    v_mfma_f32_16x16x32_bf16 v[24:27], a[96:99], a[132:135], v[24:27]
    ds_read_b64_tr_b16 a[88:89], v6 offset:0
    s_waitcnt lgkmcnt(7)
    v_mfma_f32_16x16x32_bf16 v[28:31], a[96:99], a[136:139], v[28:31]
    s_mov_b32 m0, s38
    s_lshr_b64 s[58:59], s[58:59], 4
    s_add_u32 s39, s33, s40
    v_mfma_f32_16x16x32_bf16 v[28:31], a[80:83], a[116:119], v[28:31]
    ds_read_b64_tr_b16 a[90:91], v6 offset:1024
    s_waitcnt lgkmcnt(6)
    v_mfma_f32_16x16x32_bf16 v[32:35], a[80:83], a[120:123], v[32:35]
    buffer_load_dwordx4 v8, s[4:7], s36 offen offset:0  lds
    v_mfma_f32_16x16x32_bf16 v[32:35], a[96:99], a[140:143], v[32:35]
    ds_read_b64_tr_b16 a[104:105], v6 offset:8192
    s_waitcnt lgkmcnt(5)
    v_mfma_f32_16x16x32_bf16 v[36:39], a[96:99], a[144:147], v[36:39]
    s_mov_b32 s33, s32
    s_mov_b32 s32, s42
    s_add_u32 s31, s31, 1
    v_mfma_f32_16x16x32_bf16 v[36:39], a[80:83], a[124:127], v[36:39]
    ds_read_b64_tr_b16 a[106:107], v6 offset:9216
    s_waitcnt lgkmcnt(4)
    v_mfma_f32_16x16x32_bf16 v[40:43], a[80:83], a[128:131], v[40:43]
    buffer_load_dwordx4 v9, s[4:7], s36 offen offset:1024  lds
    v_mfma_f32_16x16x32_bf16 v[40:43], a[96:99], a[148:151], v[40:43]
    ds_read_b64_tr_b16 a[92:93], v7 offset:0
    s_cmp_lt_u32 s31, 14
    v_mfma_f32_16x16x32_bf16 v[60:63], a[100:103], a[148:151], v[60:63]
    s_cselect_b64 vcc, -1, 0
    v_add_u32 v4, s34, v4
    v_add_u32 v5, s34, v5
    v_mfma_f32_16x16x32_bf16 v[60:63], a[84:87], a[128:131], v[60:63]
    ds_read_b64_tr_b16 a[94:95], v7 offset:1024
    v_add_u32 v2, s34, v2
    v_mfma_f32_16x16x32_bf16 v[56:59], a[84:87], a[124:127], v[56:59]
    buffer_load_dwordx4 v10, s[4:7], s36 offen offset:2048  lds
    v_mfma_f32_16x16x32_bf16 v[56:59], a[100:103], a[144:147], v[56:59]
    ds_read_b64_tr_b16 a[108:109], v7 offset:8192
    v_add_u32 v3, s34, v3
    v_mfma_f32_16x16x32_bf16 v[52:55], a[100:103], a[140:143], v[52:55]
    buffer_load_dwordx4 v11, s[4:7], s36 offen offset:3072  lds
    v_mfma_f32_16x16x32_bf16 v[52:55], a[84:87], a[120:123], v[52:55]
    ds_read_b64_tr_b16 a[110:111], v7 offset:9216
    s_mov_b32 m0, s39
    v_mfma_f32_16x16x32_bf16 v[48:51], a[84:87], a[116:119], v[48:51]
    s_bitcmp1_b32 s35, s31
    v_add_u32 v6, s34, v6
    v_add_u32 v7, s34, v7
    v_mfma_f32_16x16x32_bf16 v[48:51], a[100:103], a[136:139], v[48:51]
    v_mfma_f32_16x16x32_bf16 v[44:47], a[100:103], a[132:135], v[44:47]
    buffer_load_dwordx4 v12, s[4:7], s36 offen  lds
    v_mfma_f32_16x16x32_bf16 v[44:47], a[84:87], a[112:115], v[44:47]
L_p1end:
    s_cbranch_scc1 L_aux
    s_waitcnt vmcnt(9) lgkmcnt(0)
L_auxback:
    s_cbranch_vccnz L_p1
    s_barrier
    v_mfma_f32_16x16x32_bf16 v[64:67], a[88:91], a[112:115], v[64:67]
    ds_read_b64_tr_b16 a[80:81], v4 offset:0
    s_add_u32 s42, s32, 36864
    v_mfma_f32_16x16x32_bf16 v[64:67], a[104:107], a[132:135], v[64:67]
    ds_read_b64_tr_b16 a[82:83], v4 offset:1024
    s_cmp_ge_u32 s42, 163840
    v_mfma_f32_16x16x32_bf16 v[68:71], a[104:107], a[136:139], v[68:71]
    ds_read_b64_tr_b16 a[96:97], v4 offset:8192
    s_cselect_b32 s42, 53248, s42
    v_mfma_f32_16x16x32_bf16 v[68:71], a[88:91], a[116:119], v[68:71]
    ds_read_b64_tr_b16 a[98:99], v4 offset:9216
    s_sub_u32 s34, s42, s32
    v_mfma_f32_16x16x32_bf16 v[72:75], a[88:91], a[120:123], v[72:75]
    ds_read_b64_tr_b16 a[84:85], v5 offset:0
    s_mov_b32 m0, s47
    v_mfma_f32_16x16x32_bf16 v[72:75], a[104:107], a[140:143], v[72:75]
    ds_read_b64_tr_b16 a[86:87], v5 offset:1024
    s_add_u32 s47, s47, 8192
    v_mfma_f32_16x16x32_bf16 v[76:79], a[104:107], a[144:147], v[76:79]
    ds_read_b64_tr_b16 a[100:101], v5 offset:8192
    v_mfma_f32_16x16x32_bf16 v[76:79], a[88:91], a[124:127], v[76:79]
    ds_read_b64_tr_b16 a[102:103], v5 offset:9216
    v_mfma_f32_16x16x32_bf16 v[80:83], a[88:91], a[128:131], v[80:83]
    buffer_load_dwordx4 v17, s[12:15], s55 offen nt lds
    v_mfma_f32_16x16x32_bf16 v[80:83], a[104:107], a[148:151], v[80:83]
    s_add_u32 m0, m0, 4096
    s_add_u32 s48, s48, 4096
    v_mfma_f32_16x16x32_bf16 v[84:87], a[108:111], a[132:135], v[84:87]
    ds_read_b128 a[132:135], v3 offset:0
    v_mfma_f32_16x16x32_bf16 v[84:87], a[92:95], a[112:115], v[84:87]
    ds_read_b128 a[112:115], v2 offset:0
    v_mfma_f32_16x16x32_bf16 v[88:91], a[92:95], a[116:119], v[88:91]
    ds_read_b128 a[116:119], v2 offset:2048
    v_mfma_f32_16x16x32_bf16 v[88:91], a[108:111], a[136:139], v[88:91]
    ds_read_b128 a[136:139], v3 offset:2048
    v_mfma_f32_16x16x32_bf16 v[92:95], a[108:111], a[140:143], v[92:95]
    ds_read_b128 a[140:143], v3 offset:4096
    v_mfma_f32_16x16x32_bf16 v[92:95], a[92:95], a[120:123], v[92:95]
    ds_read_b128 a[120:123], v2 offset:4096
    v_mfma_f32_16x16x32_bf16 v[96:99], a[92:95], a[124:127], v[96:99]
    ds_read_b128 a[124:127], v2 offset:6144
    v_mfma_f32_16x16x32_bf16 v[96:99], a[108:111], a[144:147], v[96:99]
    ds_read_b128 a[144:147], v3 offset:6144
    v_mfma_f32_16x16x32_bf16 v[100:103], a[108:111], a[148:151], v[100:103]
    ds_read_b128 a[148:151], v3 offset:8192
    v_mfma_f32_16x16x32_bf16 v[100:103], a[92:95], a[128:131], v[100:103]
    ds_read_b128 a[128:131], v2 offset:8192
    s_waitcnt lgkmcnt(8)
    v_mfma_f32_16x16x32_bf16 v[24:27], a[80:83], a[112:115], v[24:27]
    buffer_load_dwordx4 v17, s[16:19], s55 offen nt lds
    v_mfma_f32_16x16x32_bf16 v[24:27], a[96:99], a[132:135], v[24:27]
    ds_read_b64_tr_b16 a[88:89], v6 offset:0
    s_waitcnt lgkmcnt(7)
    v_mfma_f32_16x16x32_bf16 v[28:31], a[96:99], a[136:139], v[28:31]
    s_xor_b32 s55, s48, s66
    s_mov_b32 m0, s47
    s_add_u32 s47, s47, 8192
    v_mfma_f32_16x16x32_bf16 v[28:31], a[80:83], a[116:119], v[28:31]
    ds_read_b64_tr_b16 a[90:91], v6 offset:1024
    s_waitcnt lgkmcnt(6)
    v_mfma_f32_16x16x32_bf16 v[32:35], a[80:83], a[120:123], v[32:35]
    v_add_u32 v4, s34, v4
    v_add_u32 v5, s34, v5
    v_add_u32 v2, s34, v2
    v_mfma_f32_16x16x32_bf16 v[32:35], a[96:99], a[140:143], v[32:35]
    ds_read_b64_tr_b16 a[104:105], v6 offset:8192
    s_waitcnt lgkmcnt(5)
    v_mfma_f32_16x16x32_bf16 v[36:39], a[96:99], a[144:147], v[36:39]
    v_add_u32 v3, s34, v3
    v_mfma_f32_16x16x32_bf16 v[36:39], a[80:83], a[124:127], v[36:39]
    ds_read_b64_tr_b16 a[106:107], v6 offset:9216
    s_waitcnt lgkmcnt(4)
    v_mfma_f32_16x16x32_bf16 v[40:43], a[80:83], a[128:131], v[40:43]
    buffer_load_dwordx4 v17, s[12:15], s55 offen nt lds
    v_mfma_f32_16x16x32_bf16 v[40:43], a[96:99], a[148:151], v[40:43]
    ds_read_b64_tr_b16 a[92:93], v7 offset:0
    s_add_u32 m0, m0, 4096
    v_mfma_f32_16x16x32_bf16 v[60:63], a[100:103], a[148:151], v[60:63]
    s_add_u32 s48, s48, 4096
    v_add_u32 v6, s34, v6
    v_mfma_f32_16x16x32_bf16 v[60:63], a[84:87], a[128:131], v[60:63]
    ds_read_b64_tr_b16 a[94:95], v7 offset:1024
    v_mfma_f32_16x16x32_bf16 v[56:59], a[84:87], a[124:127], v[56:59]
    v_mfma_f32_16x16x32_bf16 v[56:59], a[100:103], a[144:147], v[56:59]
    ds_read_b64_tr_b16 a[108:109], v7 offset:8192
    v_mfma_f32_16x16x32_bf16 v[52:55], a[100:103], a[140:143], v[52:55]
    v_mfma_f32_16x16x32_bf16 v[52:55], a[84:87], a[120:123], v[52:55]
    ds_read_b64_tr_b16 a[110:111], v7 offset:9216
    v_add_u32 v7, s34, v7
    v_mfma_f32_16x16x32_bf16 v[48:51], a[84:87], a[116:119], v[48:51]
    buffer_load_dwordx4 v17, s[16:19], s55 offen nt lds
    v_mfma_f32_16x16x32_bf16 v[48:51], a[100:103], a[136:139], v[48:51]
    s_xor_b32 s55, s48, s66
    v_mfma_f32_16x16x32_bf16 v[44:47], a[100:103], a[132:135], v[44:47]
    v_mfma_f32_16x16x32_bf16 v[44:47], a[84:87], a[112:115], v[44:47]
    s_waitcnt vmcnt(4) lgkmcnt(0)
    s_barrier
    v_mfma_f32_16x16x32_bf16 v[64:67], a[88:91], a[112:115], v[64:67]
    ds_read_b64_tr_b16 a[80:81], v4 offset:0
    s_mov_b32 m0, s47
    v_mfma_f32_16x16x32_bf16 v[64:67], a[104:107], a[132:135], v[64:67]
    ds_read_b64_tr_b16 a[82:83], v4 offset:1024
    s_add_u32 s47, s47, 8192
    v_mfma_f32_16x16x32_bf16 v[68:71], a[104:107], a[136:139], v[68:71]
    ds_read_b64_tr_b16 a[96:97], v4 offset:8192
    v_mfma_f32_16x16x32_bf16 v[68:71], a[88:91], a[116:119], v[68:71]
    ds_read_b64_tr_b16 a[98:99], v4 offset:9216
    v_mfma_f32_16x16x32_bf16 v[72:75], a[88:91], a[120:123], v[72:75]
    ds_read_b64_tr_b16 a[84:85], v5 offset:0
    v_mfma_f32_16x16x32_bf16 v[72:75], a[104:107], a[140:143], v[72:75]
    ds_read_b64_tr_b16 a[86:87], v5 offset:1024
    v_mfma_f32_16x16x32_bf16 v[76:79], a[104:107], a[144:147], v[76:79]
    ds_read_b64_tr_b16 a[100:101], v5 offset:8192
    v_mfma_f32_16x16x32_bf16 v[76:79], a[88:91], a[124:127], v[76:79]
    ds_read_b64_tr_b16 a[102:103], v5 offset:9216
    v_mfma_f32_16x16x32_bf16 v[80:83], a[88:91], a[128:131], v[80:83]
    buffer_load_dwordx4 v17, s[12:15], s55 offen nt lds
    v_mfma_f32_16x16x32_bf16 v[80:83], a[104:107], a[148:151], v[80:83]
    s_add_u32 m0, m0, 4096
    s_add_u32 s48, s48, 4096
    v_mfma_f32_16x16x32_bf16 v[84:87], a[108:111], a[132:135], v[84:87]
    ds_read_b128 a[132:135], v3 offset:0
    v_mfma_f32_16x16x32_bf16 v[84:87], a[92:95], a[112:115], v[84:87]
    ds_read_b128 a[112:115], v2 offset:0
    v_mfma_f32_16x16x32_bf16 v[88:91], a[92:95], a[116:119], v[88:91]
    ds_read_b128 a[116:119], v2 offset:2048
    v_mfma_f32_16x16x32_bf16 v[88:91], a[108:111], a[136:139], v[88:91]
    ds_read_b128 a[136:139], v3 offset:2048
    v_mfma_f32_16x16x32_bf16 v[92:95], a[108:111], a[140:143], v[92:95]
    ds_read_b128 a[140:143], v3 offset:4096
    v_mfma_f32_16x16x32_bf16 v[92:95], a[92:95], a[120:123], v[92:95]
    ds_read_b128 a[120:123], v2 offset:4096
    v_mfma_f32_16x16x32_bf16 v[96:99], a[92:95], a[124:127], v[96:99]
    ds_read_b128 a[124:127], v2 offset:6144
    v_mfma_f32_16x16x32_bf16 v[96:99], a[108:111], a[144:147], v[96:99]
    ds_read_b128 a[144:147], v3 offset:6144
    v_mfma_f32_16x16x32_bf16 v[100:103], a[108:111], a[148:151], v[100:103]
    ds_read_b128 a[148:151], v3 offset:8192
    v_mfma_f32_16x16x32_bf16 v[100:103], a[92:95], a[128:131], v[100:103]
    ds_read_b128 a[128:131], v2 offset:8192
    s_waitcnt lgkmcnt(8)
    v_mfma_f32_16x16x32_bf16 v[24:27], a[80:83], a[112:115], v[24:27]
    buffer_load_dwordx4 v17, s[16:19], s55 offen nt lds
    v_mfma_f32_16x16x32_bf16 v[24:27], a[96:99], a[132:135], v[24:27]
    ds_read_b64_tr_b16 a[88:89], v6 offset:0
    s_waitcnt lgkmcnt(7)
    v_mfma_f32_16x16x32_bf16 v[28:31], a[96:99], a[136:139], v[28:31]
    ds_read_b128 a[240:243], v23 offset:0
    v_mfma_f32_16x16x32_bf16 v[28:31], a[80:83], a[116:119], v[28:31]
    ds_read_b64_tr_b16 a[90:91], v6 offset:1024
    s_waitcnt lgkmcnt(7)
    v_mfma_f32_16x16x32_bf16 v[32:35], a[80:83], a[120:123], v[32:35]
    ds_read_b128 a[244:247], v23 offset:64
    v_mfma_f32_16x16x32_bf16 v[32:35], a[96:99], a[140:143], v[32:35]
    ds_read_b64_tr_b16 a[104:105], v6 offset:8192
    s_waitcnt lgkmcnt(7)
    v_mfma_f32_16x16x32_bf16 v[36:39], a[96:99], a[144:147], v[36:39]
    ds_read_b128 a[248:251], v23 offset:128
    v_mfma_f32_16x16x32_bf16 v[36:39], a[80:83], a[124:127], v[36:39]
    ds_read_b64_tr_b16 a[106:107], v6 offset:9216
    s_xor_b32 s55, s48, s66
    s_mov_b32 m0, s47
    s_add_u32 s47, s47, 8192
    s_waitcnt lgkmcnt(7)
    v_mfma_f32_16x16x32_bf16 v[40:43], a[80:83], a[128:131], v[40:43]
    buffer_load_dwordx4 v17, s[12:15], s55 offen nt lds
    v_mfma_f32_16x16x32_bf16 v[40:43], a[96:99], a[148:151], v[40:43]
    ds_read_b64_tr_b16 a[92:93], v7 offset:0
    s_add_u32 m0, m0, 4096
    v_mfma_f32_16x16x32_bf16 v[60:63], a[100:103], a[148:151], v[60:63]
    ds_read_b128 a[252:255], v23 offset:192
    v_mfma_f32_16x16x32_bf16 v[60:63], a[84:87], a[128:131], v[60:63]
    ds_read_b64_tr_b16 a[94:95], v7 offset:1024
    s_add_u32 s48, s48, 4096
    v_mfma_f32_16x16x32_bf16 v[56:59], a[84:87], a[124:127], v[56:59]
    ds_read_b128 a[160:163], v184 offset:0
    v_mfma_f32_16x16x32_bf16 v[56:59], a[100:103], a[144:147], v[56:59]
    ds_read_b64_tr_b16 a[108:109], v7 offset:8192
    v_mfma_f32_16x16x32_bf16 v[52:55], a[100:103], a[140:143], v[52:55]
    ds_read_b128 a[164:167], v185 offset:0
    v_mfma_f32_16x16x32_bf16 v[52:55], a[84:87], a[120:123], v[52:55]
    ds_read_b64_tr_b16 a[110:111], v7 offset:9216
    v_mfma_f32_16x16x32_bf16 v[48:51], a[84:87], a[116:119], v[48:51]
    buffer_load_dwordx4 v17, s[16:19], s55 offen nt lds
    v_mfma_f32_16x16x32_bf16 v[48:51], a[100:103], a[136:139], v[48:51]
    s_xor_b32 s55, s48, s66
    v_mfma_f32_16x16x32_bf16 v[44:47], a[100:103], a[132:135], v[44:47]
    ds_read_b128 a[168:171], v186 offset:0
    v_mfma_f32_16x16x32_bf16 v[44:47], a[84:87], a[112:115], v[44:47]
    ds_read_b128 a[172:175], v187 offset:0
    s_waitcnt lgkmcnt(2)
    s_barrier
    s_mov_b32 s92, s53
    s_mov_b32 s93, s53
    v_mfma_f32_16x16x32_bf16 v[64:67], a[88:91], a[112:115], v[64:67]
    buffer_load_dwordx2 v[18:19], v240, s[24:27], 0 offen sc0 sc1
    v_mfma_f32_16x16x32_bf16 v[64:67], a[104:107], a[132:135], v[64:67]
    v_mul_f32 v24, s53, v24
    v_mul_f32 v25, s53, v25
    v_mul_f32 v26, s53, v26
    v_mul_f32 v27, s53, v27
    v_cvt_pk_bf16_f32 v24, v24, v25
    v_cvt_pk_bf16_f32 v25, v26, v27
    v_mfma_f32_16x16x32_bf16 v[68:71], a[104:107], a[136:139], v[68:71]
    ds_read_b128 a[176:179], v184 offset:8192
    v_mfma_f32_16x16x32_bf16 v[68:71], a[88:91], a[116:119], v[68:71]
    ds_write_b64 v21, v[24:25] offset:0
    v_mul_f32 v28, s53, v28
    v_mul_f32 v29, s53, v29
    v_mul_f32 v30, s53, v30
    v_mul_f32 v31, s53, v31
    v_cvt_pk_bf16_f32 v28, v28, v29
    v_cvt_pk_bf16_f32 v29, v30, v31
    v_mfma_f32_16x16x32_bf16 v[72:75], a[88:91], a[120:123], v[72:75]
    ds_read_b128 a[180:183], v185 offset:8192
    v_mfma_f32_16x16x32_bf16 v[72:75], a[104:107], a[140:143], v[72:75]
    ds_write_b64 v21, v[28:29] offset:4096
    v_mul_f32 v32, s53, v32
    v_mul_f32 v33, s53, v33
    v_mul_f32 v34, s53, v34
    v_mul_f32 v35, s53, v35
    v_cvt_pk_bf16_f32 v32, v32, v33
    v_cvt_pk_bf16_f32 v33, v34, v35
    v_mfma_f32_16x16x32_bf16 v[76:79], a[104:107], a[144:147], v[76:79]
    ds_read_b128 a[184:187], v186 offset:8192
    v_mfma_f32_16x16x32_bf16 v[76:79], a[88:91], a[124:127], v[76:79]
    ds_write_b64 v21, v[32:33] offset:8192
    v_mul_f32 v36, s53, v36
    v_mul_f32 v37, s53, v37
    v_mul_f32 v38, s53, v38
    v_mul_f32 v39, s53, v39
    v_cvt_pk_bf16_f32 v36, v36, v37
    v_cvt_pk_bf16_f32 v37, v38, v39
    v_mfma_f32_16x16x32_bf16 v[80:83], a[88:91], a[128:131], v[80:83]
    ds_read_b128 a[188:191], v187 offset:8192
    s_mov_b32 m0, s47
    s_add_u32 s47, s47, 8192
    buffer_load_dwordx4 v17, s[12:15], s55 offen nt lds
    s_add_u32 m0, m0, 4096
    s_add_u32 s48, s48, 4096
    buffer_load_dwordx4 v17, s[16:19], s55 offen nt lds
    s_xor_b32 s55, s48, s66
    v_mfma_f32_16x16x32_bf16 v[80:83], a[104:107], a[148:151], v[80:83]
    ds_write_b64 v21, v[36:37] offset:12288
    v_mul_f32 v40, s53, v40
    v_mul_f32 v41, s53, v41
    v_mul_f32 v42, s53, v42
    v_mul_f32 v43, s53, v43
    v_cvt_pk_bf16_f32 v40, v40, v41
    v_cvt_pk_bf16_f32 v41, v42, v43
    v_mfma_f32_16x16x32_bf16 v[84:87], a[108:111], a[132:135], v[84:87]
    v_mfma_f32_16x16x32_bf16 v[84:87], a[92:95], a[112:115], v[84:87]
    ds_write_b64 v21, v[40:41] offset:16384
    v_mul_f32 v60, s53, v60
    v_mul_f32 v61, s53, v61
    v_mul_f32 v62, s53, v62
    v_mul_f32 v63, s53, v63
    v_cvt_pk_bf16_f32 v60, v60, v61
    v_cvt_pk_bf16_f32 v61, v62, v63
    v_mfma_f32_16x16x32_bf16 v[88:91], a[92:95], a[116:119], v[88:91]
    v_mfma_f32_16x16x32_bf16 v[88:91], a[108:111], a[136:139], v[88:91]
    ds_write_b64 v21, v[60:61] offset:16896
    v_mul_f32 v56, s53, v56
    v_mul_f32 v57, s53, v57
    v_mul_f32 v58, s53, v58
    v_mul_f32 v59, s53, v59
    v_cvt_pk_bf16_f32 v56, v56, v57
    v_cvt_pk_bf16_f32 v57, v58, v59
    v_mfma_f32_16x16x32_bf16 v[92:95], a[108:111], a[140:143], v[92:95]
    v_mfma_f32_16x16x32_bf16 v[92:95], a[92:95], a[120:123], v[92:95]
    ds_write_b64 v21, v[56:57] offset:12800
    v_mul_f32 v52, s53, v52
    v_mul_f32 v53, s53, v53
    v_mul_f32 v54, s53, v54
    v_mul_f32 v55, s53, v55
    v_cvt_pk_bf16_f32 v52, v52, v53
    v_cvt_pk_bf16_f32 v53, v54, v55
    v_mfma_f32_16x16x32_bf16 v[96:99], a[92:95], a[124:127], v[96:99]
    s_mov_b32 m0, s47
    s_add_u32 s47, s47, 8192
    buffer_load_dwordx4 v17, s[12:15], s55 offen nt lds
    s_add_u32 m0, m0, 4096
    s_add_u32 s48, s48, 4096
    buffer_load_dwordx4 v17, s[16:19], s55 offen nt lds
    s_xor_b32 s55, s48, s66
    v_mfma_f32_16x16x32_bf16 v[96:99], a[108:111], a[144:147], v[96:99]
    ds_write_b64 v21, v[52:53] offset:8704
    v_mul_f32 v48, s53, v48
    v_mul_f32 v49, s53, v49
    v_mul_f32 v50, s53, v50
    v_mul_f32 v51, s53, v51
    v_cvt_pk_bf16_f32 v48, v48, v49
    v_cvt_pk_bf16_f32 v49, v50, v51
    v_mfma_f32_16x16x32_bf16 v[100:103], a[108:111], a[148:151], v[100:103]
    v_mfma_f32_16x16x32_bf16 v[100:103], a[92:95], a[128:131], v[100:103]
    ds_write_b64 v21, v[48:49] offset:4608
    v_mul_f32 v44, s53, v44
    v_mul_f32 v45, s53, v45
    v_mul_f32 v46, s53, v46
    v_mul_f32 v47, s53, v47
    v_cvt_pk_bf16_f32 v44, v44, v45
    v_cvt_pk_bf16_f32 v45, v46, v47
    ds_write_b64 v21, v[44:45] offset:512
    v_pk_mul_f32 v[64:65], v[64:65], s[92:93]
    v_pk_mul_f32 v[66:67], v[66:67], s[92:93]
    v_cvt_pk_bf16_f32 v64, v64, v65
    v_cvt_pk_bf16_f32 v65, v66, v67
    ds_write_b64 v21, v[64:65] offset:1024
    v_pk_mul_f32 v[68:69], v[68:69], s[92:93]
    v_pk_mul_f32 v[70:71], v[70:71], s[92:93]
    v_cvt_pk_bf16_f32 v68, v68, v69
    v_cvt_pk_bf16_f32 v69, v70, v71
    ds_write_b64 v21, v[68:69] offset:5120
    v_pk_mul_f32 v[72:73], v[72:73], s[92:93]
    v_pk_mul_f32 v[74:75], v[74:75], s[92:93]
    v_cvt_pk_bf16_f32 v72, v72, v73
    v_cvt_pk_bf16_f32 v73, v74, v75
    ds_write_b64 v21, v[72:73] offset:9216
    v_pk_mul_f32 v[76:77], v[76:77], s[92:93]
    v_pk_mul_f32 v[78:79], v[78:79], s[92:93]
    v_cvt_pk_bf16_f32 v76, v76, v77
    v_cvt_pk_bf16_f32 v77, v78, v79
    ds_write_b64 v21, v[76:77] offset:13312
    v_pk_mul_f32 v[80:81], v[80:81], s[92:93]
    v_pk_mul_f32 v[82:83], v[82:83], s[92:93]
    v_cvt_pk_bf16_f32 v80, v80, v81
    v_cvt_pk_bf16_f32 v81, v82, v83
    ds_write_b64 v21, v[80:81] offset:17408
    v_pk_mul_f32 v[84:85], v[84:85], s[92:93]
    v_pk_mul_f32 v[86:87], v[86:87], s[92:93]
    v_cvt_pk_bf16_f32 v84, v84, v85
    v_cvt_pk_bf16_f32 v85, v86, v87
    ds_write_b64 v21, v[84:85] offset:1536
    v_pk_mul_f32 v[88:89], v[88:89], s[92:93]
    v_pk_mul_f32 v[90:91], v[90:91], s[92:93]
    v_cvt_pk_bf16_f32 v88, v88, v89
    v_cvt_pk_bf16_f32 v89, v90, v91
    ds_write_b64 v21, v[88:89] offset:5632
    v_pk_mul_f32 v[92:93], v[92:93], s[92:93]
    v_pk_mul_f32 v[94:95], v[94:95], s[92:93]
    v_cvt_pk_bf16_f32 v92, v92, v93
    v_cvt_pk_bf16_f32 v93, v94, v95
    ds_write_b64 v21, v[92:93] offset:9728
    v_pk_mul_f32 v[96:97], v[96:97], s[92:93]
    v_pk_mul_f32 v[98:99], v[98:99], s[92:93]
    v_cvt_pk_bf16_f32 v96, v96, v97
    v_cvt_pk_bf16_f32 v97, v98, v99
    ds_write_b64 v21, v[96:97] offset:13824
    v_pk_mul_f32 v[100:101], v[100:101], s[92:93]
    v_pk_mul_f32 v[102:103], v[102:103], s[92:93]
    v_cvt_pk_bf16_f32 v100, v100, v101
    v_cvt_pk_bf16_f32 v101, v102, v103
    ds_write_b64 v21, v[100:101] offset:17920
    s_add_u32 s41, s45, 122880
    v_add_u32 v21, s41, v20
    s_waitcnt lgkmcnt(0)
    s_barrier
    ds_read_b128 a[80:83], v22 offset:0
    ds_read_b128 a[84:87], v22 offset:1024
    ds_read_b128 a[88:91], v22 offset:2048
    ds_read_b128 a[92:95], v22 offset:3072
    ds_read_b128 a[96:99], v22 offset:4096
    ds_read_b128 a[100:103], v22 offset:5120
    ds_read_b128 a[104:107], v22 offset:6144
    ds_read_b128 a[108:111], v22 offset:7168
    ds_read_b128 a[112:115], v22 offset:8192
    ds_read_b128 a[116:119], v22 offset:9216
    s_mov_b32 m0, s47
    s_add_u32 s47, s47, 8192
    buffer_load_dwordx4 v17, s[12:15], s55 offen nt lds
    s_add_u32 m0, m0, 4096
    s_add_u32 s48, s48, 4096
    buffer_load_dwordx4 v17, s[16:19], s55 offen nt lds
    s_xor_b32 s55, s48, s66
    s_waitcnt lgkmcnt(9)
    v_mfma_f32_16x16x32_bf16 v[196:199], a[240:243], a[80:83], 0
    ds_read_b128 a[120:123], v22 offset:10240
    s_waitcnt lgkmcnt(9)
    v_mfma_f32_16x16x32_bf16 v[196:199], a[244:247], a[84:87], v[196:199]
    ds_read_b128 a[124:127], v22 offset:11264
    s_waitcnt lgkmcnt(9)
    v_mfma_f32_16x16x32_bf16 v[196:199], a[248:251], a[88:91], v[196:199]
    ds_read_b128 a[128:131], v22 offset:12288
    s_waitcnt lgkmcnt(9)
    v_mfma_f32_16x16x32_bf16 v[196:199], a[252:255], a[92:95], v[196:199]
    ds_read_b128 a[132:135], v22 offset:13312
    s_waitcnt lgkmcnt(9)
    v_mfma_f32_16x16x32_bf16 v[200:203], a[240:243], a[96:99], 0
    ds_read_b128 a[136:139], v22 offset:14336
    s_waitcnt lgkmcnt(9)
    v_mfma_f32_16x16x32_bf16 v[200:203], a[244:247], a[100:103], v[200:203]
    ds_read_b128 a[140:143], v22 offset:15360
    s_waitcnt lgkmcnt(9)
    v_mfma_f32_16x16x32_bf16 v[200:203], a[248:251], a[104:107], v[200:203]
    ds_read_b128 a[144:147], v22 offset:16384
    s_waitcnt lgkmcnt(9)
    v_mfma_f32_16x16x32_bf16 v[200:203], a[252:255], a[108:111], v[200:203]
    ds_read_b128 a[148:151], v22 offset:17408
    s_waitcnt lgkmcnt(9)
    v_mfma_f32_16x16x32_bf16 v[204:207], a[240:243], a[112:115], 0
    ds_read_b128 a[152:155], v22 offset:18432
    v_sub_f32 v196, 0, v196
    s_waitcnt lgkmcnt(9)
    v_mfma_f32_16x16x32_bf16 v[204:207], a[244:247], a[116:119], v[204:207]
    ds_read_b128 a[156:159], v22 offset:19456
    v_sub_f32 v197, 0, v197
    s_waitcnt lgkmcnt(9)
    v_mfma_f32_16x16x32_bf16 v[204:207], a[248:251], a[120:123], v[204:207]
    v_sub_f32 v198, 0, v198
    s_waitcnt lgkmcnt(8)
    v_mfma_f32_16x16x32_bf16 v[204:207], a[252:255], a[124:127], v[204:207]
    v_sub_f32 v199, 0, v199
    s_waitcnt lgkmcnt(7)
    v_mfma_f32_16x16x32_bf16 v[208:211], a[240:243], a[128:131], 0
    v_sub_f32 v200, 0, v200
    s_waitcnt lgkmcnt(6)
    v_mfma_f32_16x16x32_bf16 v[208:211], a[244:247], a[132:135], v[208:211]
    s_waitcnt lgkmcnt(0)
    s_barrier
    v_sub_f32 v201, 0, v201
    v_mfma_f32_16x16x32_bf16 v[208:211], a[248:251], a[136:139], v[208:211]
    ds_write_b128 v21, a[192:195] offset:0
    v_sub_f32 v202, 0, v202
    v_mfma_f32_16x16x32_bf16 v[208:211], a[252:255], a[140:143], v[208:211]
    ds_write_b128 v21, a[196:199] offset:4096
    v_sub_f32 v203, 0, v203
    v_mfma_f32_16x16x32_bf16 v[212:215], a[240:243], a[144:147], 0
    ds_write_b128 v21, a[200:203] offset:8192
    v_sub_f32 v204, 0, v204
    v_mfma_f32_16x16x32_bf16 v[212:215], a[244:247], a[148:151], v[212:215]
    ds_write_b128 v21, a[204:207] offset:12288
    v_sub_f32 v205, 0, v205
    v_mfma_f32_16x16x32_bf16 v[212:215], a[248:251], a[152:155], v[212:215]
    v_sub_f32 v206, 0, v206
    v_mfma_f32_16x16x32_bf16 v[212:215], a[252:255], a[156:159], v[212:215]
    v_sub_f32 v207, 0, v207
    s_mov_b32 m0, s47
    s_add_u32 s47, s47, 8192
    buffer_load_dwordx4 v17, s[12:15], s55 offen nt lds
    s_add_u32 m0, m0, 4096
    s_add_u32 s48, s48, 4096
    buffer_load_dwordx4 v17, s[16:19], s55 offen nt lds
    s_xor_b32 s55, s48, s66
    v_mfma_f32_16x16x32_bf16 v[24:27], a[160:163], a[80:83], v[196:199]
    v_sub_f32 v208, 0, v208
    v_mfma_f32_16x16x32_bf16 v[24:27], a[164:167], a[84:87], v[24:27]
    v_sub_f32 v209, 0, v209
    v_mfma_f32_16x16x32_bf16 v[24:27], a[168:171], a[88:91], v[24:27]
    v_sub_f32 v210, 0, v210
    v_mfma_f32_16x16x32_bf16 v[24:27], a[172:175], a[92:95], v[24:27]
    v_sub_f32 v211, 0, v211
    v_mfma_f32_16x16x32_bf16 v[28:31], a[176:179], a[80:83], v[196:199]
    ds_read_b64_tr_b16 a[192:193], v188 offset:0
    v_sub_f32 v212, 0, v212
    v_mfma_f32_16x16x32_bf16 v[28:31], a[180:183], a[84:87], v[28:31]
    ds_read_b64_tr_b16 a[194:195], v188 offset:8192
    v_sub_f32 v213, 0, v213
    v_mfma_f32_16x16x32_bf16 v[28:31], a[184:187], a[88:91], v[28:31]
    ds_read_b64_tr_b16 a[196:197], v189 offset:0
    v_sub_f32 v214, 0, v214
    v_mfma_f32_16x16x32_bf16 v[28:31], a[188:191], a[92:95], v[28:31]
    ds_read_b64_tr_b16 a[198:199], v189 offset:8192
    v_sub_f32 v215, 0, v215
    s_mov_b32 m0, s47
    s_add_u32 s47, s47, 8192
    buffer_load_dwordx4 v17, s[12:15], s55 offen nt lds
    s_add_u32 m0, m0, 4096
    s_add_u32 s48, s48, 4096
    buffer_load_dwordx4 v17, s[16:19], s55 offen nt lds
    s_xor_b32 s55, s48, s66
L_p2entry:
    v_mfma_f32_16x16x32_bf16 v[32:35], a[160:163], a[96:99], v[200:203]
    ds_read_b64_tr_b16 a[200:201], v190 offset:0
    v_exp_f32 v24, v24
    v_mfma_f32_16x16x32_bf16 v[32:35], a[164:167], a[100:103], v[32:35]
    ds_read_b64_tr_b16 a[202:203], v190 offset:8192
    v_exp_f32 v25, v25
    v_mfma_f32_16x16x32_bf16 v[32:35], a[168:171], a[104:107], v[32:35]
    ds_read_b64_tr_b16 a[204:205], v191 offset:0
    v_cvt_pk_bf16_f32 v48, v24, v25
    v_exp_f32 v26, v26
    v_mfma_f32_16x16x32_bf16 v[32:35], a[172:175], a[108:111], v[32:35]
    ds_read_b64_tr_b16 a[206:207], v191 offset:8192
    v_exp_f32 v27, v27
    v_mfma_f32_16x16x32_bf16 v[36:39], a[176:179], a[96:99], v[200:203]
    v_cvt_pk_bf16_f32 v49, v26, v27
    v_exp_f32 v28, v28
    v_mfma_f32_16x16x32_bf16 v[36:39], a[180:183], a[100:103], v[36:39]
    v_exp_f32 v29, v29
    v_mfma_f32_16x16x32_bf16 v[36:39], a[184:187], a[104:107], v[36:39]
    v_cvt_pk_bf16_f32 v50, v28, v29
    v_exp_f32 v30, v30
    v_mfma_f32_16x16x32_bf16 v[36:39], a[188:191], a[108:111], v[36:39]
    v_exp_f32 v31, v31
    s_add_u32 m0, s45, 135168
    s_add_u32 s63, s45, 163840
    s_mov_b32 s48, 69632
    s_xor_b32 s55, s48, s66
    s_mov_b32 s47, 0
    s_mov_b32 s31, 0
    v_cvt_pk_bf16_f32 v51, v30, v31
.p2align 3
L_p2:
    v_mfma_f32_16x16x32_bf16 v[24:27], a[160:163], a[112:115], v[204:207]
    s_add_u32 s42, s46, 32768
    v_exp_f32 v32, v32
    v_mfma_f32_16x16x32_bf16 v[24:27], a[164:167], a[116:119], v[24:27]
    ds_read_b64_tr_b16 a[208:209], v192 offset:0
    ds_read_b64_tr_b16 a[210:211], v192 offset:8192
    v_mfma_f32_16x16x32_bf16 v[24:27], a[168:171], a[120:123], v[24:27]
    s_cmp_ge_u32 s42, 163840
    v_exp_f32 v33, v33
    v_mfma_f32_16x16x32_bf16 v[24:27], a[172:175], a[124:127], v[24:27]
    ds_read_b64_tr_b16 a[212:213], v193 offset:0
    v_cvt_pk_bf16_f32 v52, v32, v33
    v_mfma_f32_16x16x32_bf16 v[28:31], a[176:179], a[112:115], v[204:207]
    s_cselect_b32 s42, 0, s42
    v_exp_f32 v34, v34
    v_mfma_f32_16x16x32_bf16 v[28:31], a[180:183], a[116:119], v[28:31]
    ds_read_b64_tr_b16 a[214:215], v193 offset:8192
    ds_read_b64_tr_b16 a[216:217], v194 offset:0
    v_mfma_f32_16x16x32_bf16 v[28:31], a[184:187], a[120:123], v[28:31]
    s_waitcnt lgkmcnt(5)
    v_exp_f32 v35, v35
    v_mfma_f32_16x16x32_bf16 v[28:31], a[188:191], a[124:127], v[28:31]
    ds_read_b64_tr_b16 a[218:219], v194 offset:8192
    v_cvt_pk_bf16_f32 v53, v34, v35
    v_mfma_f32_16x16x32_bf16 v[104:107], a[192:195], v[48:51], v[104:107]
    s_sub_u32 s34, s42, s46
    v_exp_f32 v36, v36
    v_mfma_f32_16x16x32_bf16 v[108:111], a[196:199], v[48:51], v[108:111]
    ds_read_b64_tr_b16 a[220:221], v195 offset:0
    ds_read_b64_tr_b16 a[222:223], v195 offset:8192
    v_mfma_f32_16x16x32_bf16 v[112:115], a[200:203], v[48:51], v[112:115]
    s_mov_b32 s46, s42
    v_exp_f32 v37, v37
    v_mfma_f32_16x16x32_bf16 v[116:119], a[204:207], v[48:51], v[116:119]
    s_waitcnt lgkmcnt(4)
    v_cvt_pk_bf16_f32 v54, v36, v37
    v_add_u32 v184, s34, v184
    v_mfma_f32_16x16x32_bf16 a[0:3], a[208:211], v[48:51], a[0:3]
    s_waitcnt lgkmcnt(2)
    v_exp_f32 v38, v38
    v_mfma_f32_16x16x32_bf16 a[4:7], a[212:215], v[48:51], a[4:7]
    v_add_u32 v185, s34, v185
    v_add_u32 v186, s34, v186
    v_mfma_f32_16x16x32_bf16 a[8:11], a[216:219], v[48:51], a[8:11]
    s_waitcnt lgkmcnt(0)
    v_exp_f32 v39, v39
    v_mfma_f32_16x16x32_bf16 a[12:15], a[220:223], v[48:51], a[12:15]
    s_cmp_eq_u32 s31, 7
    v_cvt_pk_bf16_f32 v55, v38, v39
    v_add_u32 v187, s34, v187
    v_mfma_f32_16x16x32_bf16 v[216:219], a[224:227], v[48:51], v[216:219]
    s_cbranch_scc1 L_tail
    v_add_u32 v188, s34, v188
    v_add_u32 v189, s34, v189
    v_mfma_f32_16x16x32_bf16 v[32:35], a[160:163], a[128:131], v[208:211]
    s_bitcmp1_b32 56, s31
    v_exp_f32 v24, v24
    v_mfma_f32_16x16x32_bf16 v[32:35], a[164:167], a[132:135], v[32:35]
    s_cbranch_scc1 L_xtra
L_xtraback:
    v_mfma_f32_16x16x32_bf16 v[32:35], a[168:171], a[136:139], v[32:35]
    v_exp_f32 v25, v25
    v_mfma_f32_16x16x32_bf16 v[32:35], a[172:175], a[140:143], v[32:35]
    v_cvt_pk_bf16_f32 v48, v24, v25
    v_add_u32 v190, s34, v190
    v_mfma_f32_16x16x32_bf16 v[36:39], a[176:179], a[128:131], v[208:211]
    v_exp_f32 v26, v26
    v_mfma_f32_16x16x32_bf16 v[36:39], a[180:183], a[132:135], v[36:39]
    v_add_u32 v191, s34, v191
    v_add_u32 v192, s34, v192
    v_mfma_f32_16x16x32_bf16 v[36:39], a[184:187], a[136:139], v[36:39]
    v_exp_f32 v27, v27
    v_mfma_f32_16x16x32_bf16 v[36:39], a[188:191], a[140:143], v[36:39]
    v_cvt_pk_bf16_f32 v49, v26, v27
    v_add_u32 v193, s34, v193
    v_mfma_f32_16x16x32_bf16 v[120:123], a[192:195], v[52:55], v[120:123]
    v_exp_f32 v28, v28
    v_mfma_f32_16x16x32_bf16 v[124:127], a[196:199], v[52:55], v[124:127]
    v_mfma_f32_16x16x32_bf16 v[128:131], a[200:203], v[52:55], v[128:131]
    v_exp_f32 v29, v29
    v_mfma_f32_16x16x32_bf16 v[132:135], a[204:207], v[52:55], v[132:135]
    v_cvt_pk_bf16_f32 v50, v28, v29
    v_mfma_f32_16x16x32_bf16 a[16:19], a[208:211], v[52:55], a[16:19]
    v_exp_f32 v30, v30
    v_mfma_f32_16x16x32_bf16 a[20:23], a[212:215], v[52:55], a[20:23]
    v_mfma_f32_16x16x32_bf16 a[24:27], a[216:219], v[52:55], a[24:27]
    s_cmp_ge_u32 s31, 5
    v_exp_f32 v31, v31
    v_mfma_f32_16x16x32_bf16 a[28:31], a[220:223], v[52:55], a[28:31]
    v_cvt_pk_bf16_f32 v51, v30, v31
    v_mfma_f32_16x16x32_bf16 v[220:223], a[224:227], v[52:55], v[220:223]
    s_cbranch_scc1 L_p2late
    s_waitcnt vmcnt(6)
L_p2bar:
    s_barrier
    v_mfma_f32_16x16x32_bf16 v[40:43], a[160:163], a[144:147], v[212:215]
    v_exp_f32 v32, v32
    v_mfma_f32_16x16x32_bf16 v[40:43], a[164:167], a[148:151], v[40:43]
    ds_read_b128 a[160:163], v184 offset:0
    v_add_u32 v194, s34, v194
    v_mfma_f32_16x16x32_bf16 v[40:43], a[168:171], a[152:155], v[40:43]
    v_exp_f32 v33, v33
    v_mfma_f32_16x16x32_bf16 v[40:43], a[172:175], a[156:159], v[40:43]
    ds_read_b128 a[164:167], v185 offset:0
    v_cvt_pk_bf16_f32 v52, v32, v33
    v_mfma_f32_16x16x32_bf16 v[44:47], a[176:179], a[144:147], v[212:215]
    v_exp_f32 v34, v34
    v_mfma_f32_16x16x32_bf16 v[44:47], a[180:183], a[148:151], v[44:47]
    ds_read_b128 a[168:171], v186 offset:0
    v_add_u32 v195, s34, v195
    v_mfma_f32_16x16x32_bf16 v[44:47], a[184:187], a[152:155], v[44:47]
    s_add_u32 s31, s31, 1
    v_exp_f32 v35, v35
    v_mfma_f32_16x16x32_bf16 v[44:47], a[188:191], a[156:159], v[44:47]
    ds_read_b128 a[172:175], v187 offset:0
    v_cvt_pk_bf16_f32 v53, v34, v35
    v_mfma_f32_16x16x32_bf16 v[136:139], a[192:195], v[48:51], v[136:139]
    s_add_u32 m0, m0, 4096
    v_exp_f32 v36, v36
    v_mfma_f32_16x16x32_bf16 v[140:143], a[196:199], v[48:51], v[140:143]
    ds_read_b128 a[176:179], v184 offset:8192
    v_mfma_f32_16x16x32_bf16 v[144:147], a[200:203], v[48:51], v[144:147]
    s_cmp_eq_u32 m0, s63
    v_exp_f32 v37, v37
    v_mfma_f32_16x16x32_bf16 v[148:151], a[204:207], v[48:51], v[148:151]
    ds_read_b128 a[180:183], v185 offset:8192
    v_cvt_pk_bf16_f32 v54, v36, v37
    v_mfma_f32_16x16x32_bf16 a[32:35], a[208:211], v[48:51], a[32:35]
    s_cselect_b32 m0, s45, m0
    v_exp_f32 v38, v38
    v_mfma_f32_16x16x32_bf16 a[36:39], a[212:215], v[48:51], a[36:39]
    ds_read_b128 a[184:187], v186 offset:8192
    v_mfma_f32_16x16x32_bf16 a[40:43], a[216:219], v[48:51], a[40:43]
    v_exp_f32 v39, v39
    v_mfma_f32_16x16x32_bf16 a[44:47], a[220:223], v[48:51], a[44:47]
    ds_read_b128 a[188:191], v187 offset:8192
    v_cvt_pk_bf16_f32 v55, v38, v39
    v_mfma_f32_16x16x32_bf16 v[224:227], a[224:227], v[48:51], v[224:227]
    s_waitcnt lgkmcnt(3)
    v_mfma_f32_16x16x32_bf16 v[24:27], a[160:163], a[80:83], v[196:199]
    v_exp_f32 v40, v40
    v_mfma_f32_16x16x32_bf16 v[24:27], a[164:167], a[84:87], v[24:27]
    buffer_load_dwordx4 v17, s[12:15], s55 offen nt lds
    v_mfma_f32_16x16x32_bf16 v[24:27], a[168:171], a[88:91], v[24:27]
    s_add_u32 m0, m0, 4096
    v_exp_f32 v41, v41
    v_mfma_f32_16x16x32_bf16 v[24:27], a[172:175], a[92:95], v[24:27]
    s_waitcnt lgkmcnt(0)
    v_cvt_pk_bf16_f32 v56, v40, v41
    v_mfma_f32_16x16x32_bf16 v[28:31], a[176:179], a[80:83], v[196:199]
    s_add_u32 s48, s48, 4096
    v_exp_f32 v42, v42
    v_mfma_f32_16x16x32_bf16 v[28:31], a[180:183], a[84:87], v[28:31]
    buffer_load_dwordx4 v17, s[16:19], s55 offen nt lds
    v_mfma_f32_16x16x32_bf16 v[28:31], a[184:187], a[88:91], v[28:31]
    s_xor_b32 s55, s48, s66
    v_exp_f32 v43, v43
    v_mfma_f32_16x16x32_bf16 v[28:31], a[188:191], a[92:95], v[28:31]
    s_add_u32 m0, m0, 4096
    s_cmp_eq_u32 m0, s63
    v_cvt_pk_bf16_f32 v57, v42, v43
    v_mfma_f32_16x16x32_bf16 v[152:155], a[192:195], v[52:55], v[152:155]
    s_cselect_b32 m0, s45, m0
    v_exp_f32 v44, v44
    v_mfma_f32_16x16x32_bf16 v[156:159], a[196:199], v[52:55], v[156:159]
    buffer_load_dwordx4 v17, s[12:15], s55 offen nt lds
    v_mfma_f32_16x16x32_bf16 v[160:163], a[200:203], v[52:55], v[160:163]
    s_add_u32 m0, m0, 4096
    v_exp_f32 v45, v45
    v_mfma_f32_16x16x32_bf16 v[164:167], a[204:207], v[52:55], v[164:167]
    v_cvt_pk_bf16_f32 v58, v44, v45
    v_mfma_f32_16x16x32_bf16 a[48:51], a[208:211], v[52:55], a[48:51]
    s_add_u32 s48, s48, 4096
    v_exp_f32 v46, v46
    v_mfma_f32_16x16x32_bf16 a[52:55], a[212:215], v[52:55], a[52:55]
    buffer_load_dwordx4 v17, s[16:19], s55 offen nt lds
    v_mfma_f32_16x16x32_bf16 a[56:59], a[216:219], v[52:55], a[56:59]
    s_xor_b32 s55, s48, s66
    v_exp_f32 v47, v47
    v_mfma_f32_16x16x32_bf16 a[60:63], a[220:223], v[52:55], a[60:63]
    v_cvt_pk_bf16_f32 v59, v46, v47
    v_mfma_f32_16x16x32_bf16 v[228:231], a[224:227], v[52:55], v[228:231]
    v_mfma_f32_16x16x32_bf16 v[32:35], a[160:163], a[96:99], v[200:203]
    v_exp_f32 v24, v24
    v_mfma_f32_16x16x32_bf16 v[32:35], a[164:167], a[100:103], v[32:35]
    v_mfma_f32_16x16x32_bf16 v[32:35], a[168:171], a[104:107], v[32:35]
    v_exp_f32 v25, v25
    v_mfma_f32_16x16x32_bf16 v[32:35], a[172:175], a[108:111], v[32:35]
    v_cvt_pk_bf16_f32 v48, v24, v25
    v_mfma_f32_16x16x32_bf16 v[36:39], a[176:179], a[96:99], v[200:203]
    v_exp_f32 v26, v26
    v_mfma_f32_16x16x32_bf16 v[36:39], a[180:183], a[100:103], v[36:39]
    v_mfma_f32_16x16x32_bf16 v[36:39], a[184:187], a[104:107], v[36:39]
    v_exp_f32 v27, v27
    v_mfma_f32_16x16x32_bf16 v[36:39], a[188:191], a[108:111], v[36:39]
    v_cvt_pk_bf16_f32 v49, v26, v27
    v_mfma_f32_16x16x32_bf16 v[168:171], a[192:195], v[56:59], v[168:171]
    v_exp_f32 v28, v28
    v_mfma_f32_16x16x32_bf16 v[172:175], a[196:199], v[56:59], v[172:175]
    ds_read_b64_tr_b16 a[192:193], v188 offset:0
    ds_read_b64_tr_b16 a[194:195], v188 offset:8192
    v_mfma_f32_16x16x32_bf16 v[176:179], a[200:203], v[56:59], v[176:179]
    v_exp_f32 v29, v29
    v_mfma_f32_16x16x32_bf16 v[180:183], a[204:207], v[56:59], v[180:183]
    ds_read_b64_tr_b16 a[196:197], v189 offset:0
    v_cvt_pk_bf16_f32 v50, v28, v29
    v_mfma_f32_16x16x32_bf16 a[64:67], a[208:211], v[56:59], a[64:67]
    v_exp_f32 v30, v30
    v_mfma_f32_16x16x32_bf16 a[68:71], a[212:215], v[56:59], a[68:71]
    ds_read_b64_tr_b16 a[198:199], v189 offset:8192
    ds_read_b64_tr_b16 a[200:201], v190 offset:0
    v_mfma_f32_16x16x32_bf16 a[72:75], a[216:219], v[56:59], a[72:75]
    v_exp_f32 v31, v31
    v_mfma_f32_16x16x32_bf16 a[76:79], a[220:223], v[56:59], a[76:79]
    ds_read_b64_tr_b16 a[202:203], v190 offset:8192
    v_cvt_pk_bf16_f32 v51, v30, v31
    v_mfma_f32_16x16x32_bf16 v[232:235], a[224:227], v[56:59], v[232:235]
    ds_read_b64_tr_b16 a[204:205], v191 offset:0
    ds_read_b64_tr_b16 a[206:207], v191 offset:8192
    s_branch L_p2
L_p2late:
    s_waitcnt vmcnt(4)
    s_cmp_eq_u32 s31, 5
    s_cbranch_scc1 L_p2bar
    s_waitcnt vmcnt(0)
    buffer_load_dword a228, v237, s[76:79], 0 offen
    s_branch L_p2bar
L_tail:
    s_mul_i32 s41, s28, 20480
    v_add_u32 v21, s41, v20
    s_waitcnt vmcnt(0)
    s_barrier
    v_mfma_f32_16x16x32_bf16 v[32:35], a[160:163], a[128:131], v[208:211]
    s_add_u32 m0, s44, 110592
    s_lshl_b32 s37, s61, 18
    v_exp_f32 v24, v24
    v_mfma_f32_16x16x32_bf16 v[120:123], a[192:195], v[52:55], v[120:123]
    buffer_load_dwordx4 v248, s[76:79], s37 offen offset:0 lds
    buffer_load_dwordx4 v249, s[76:79], s37 offen offset:1024 lds
    v_mfma_f32_16x16x32_bf16 v[32:35], a[164:167], a[132:135], v[32:35]
    s_xor_b32 s42, s28, 2
    v_exp_f32 v25, v25
    v_mfma_f32_16x16x32_bf16 v[124:127], a[196:199], v[52:55], v[124:127]
    buffer_load_dwordx4 v250, s[76:79], s37 offen offset:2048 lds
    buffer_load_dwordx4 v251, s[76:79], s37 offen offset:3072 lds
    s_mul_i32 s41, s42, 20480
    v_cvt_pk_bf16_f32 v48, v24, v25
    v_lshlrev_b32 v23, 2, v1
    v_mfma_f32_16x16x32_bf16 v[32:35], a[168:171], a[136:139], v[32:35]
    s_mul_i32 s43, s28, 1280
    v_exp_f32 v26, v26
    v_mfma_f32_16x16x32_bf16 v[128:131], a[200:203], v[52:55], v[128:131]
    ds_write_b128 v21, a[0:3] offset:0
    v_add_u32 v22, s41, v20
    v_mfma_f32_16x16x32_bf16 v[32:35], a[172:175], a[140:143], v[32:35]
    s_add_u32 s43, s43, 65536
    v_exp_f32 v27, v27
    v_mfma_f32_16x16x32_bf16 v[132:135], a[204:207], v[52:55], v[132:135]
    ds_write_b128 v21, a[4:7] offset:1024
    v_cvt_pk_bf16_f32 v49, v26, v27
    v_mfma_f32_16x16x32_bf16 v[36:39], a[176:179], a[128:131], v[208:211]
    s_mul_i32 s42, s42, 1280
    v_exp_f32 v28, v28
    v_mfma_f32_16x16x32_bf16 a[16:19], a[208:211], v[52:55], a[16:19]
    ds_write_b128 v21, a[8:11] offset:2048
    v_add_u32 v3, s43, v23
    v_mfma_f32_16x16x32_bf16 v[36:39], a[180:183], a[132:135], v[36:39]
    s_add_u32 s42, s42, 65536
    v_exp_f32 v29, v29
    v_mfma_f32_16x16x32_bf16 a[20:23], a[212:215], v[52:55], a[20:23]
    ds_write_b128 v21, a[12:15] offset:3072
    s_add_u32 m0, s44, 147456
    s_add_u32 s37, s37, 0x20000
    v_cvt_pk_bf16_f32 v50, v28, v29
    v_mfma_f32_16x16x32_bf16 v[36:39], a[184:187], a[136:139], v[36:39]
    s_mul_i32 s38, s57, 36864
    v_exp_f32 v30, v30
    v_mfma_f32_16x16x32_bf16 a[24:27], a[216:219], v[52:55], a[24:27]
    buffer_load_dwordx4 v248, s[76:79], s37 offen offset:0 lds
    buffer_load_dwordx4 v249, s[76:79], s37 offen offset:1024 lds
    v_mfma_f32_16x16x32_bf16 v[36:39], a[188:191], a[140:143], v[36:39]
    s_lshl_b32 s39, s28, 2
    v_exp_f32 v31, v31
    v_mfma_f32_16x16x32_bf16 a[28:31], a[220:223], v[52:55], a[28:31]
    ds_write_b32 v3, v216 offset:16384
    v_cvt_pk_bf16_f32 v51, v30, v31
    v_mfma_f32_16x16x32_bf16 v[220:223], a[224:227], v[52:55], v[220:223]
    buffer_load_dwordx4 v250, s[76:79], s37 offen offset:2048 lds
    buffer_load_dwordx4 v251, s[76:79], s37 offen offset:3072 lds
    v_and_b32 v23, 60, v23
    v_add_u32 v4, s43, v23
    v_add_u32 v5, s42, v23
    v_add_u32 v2, s38, v238
    s_waitcnt lgkmcnt(0)
    s_barrier
    v_mfma_f32_16x16x32_bf16 v[40:43], a[160:163], a[144:147], v[212:215]
    s_add_u32 s39, s39, 65536
    v_exp_f32 v32, v32
    v_mfma_f32_16x16x32_bf16 v[136:139], a[192:195], v[48:51], v[136:139]
    ds_read_b32 v196, v4 offset:16384
    ds_read_b32 v197, v5 offset:16384
    v_mov_b32 v6, s39
    v_mfma_f32_16x16x32_bf16 v[40:43], a[164:167], a[148:151], v[40:43]
    v_exp_f32 v33, v33
    v_mfma_f32_16x16x32_bf16 v[140:143], a[196:199], v[48:51], v[140:143]
    ds_read_b128 v[64:67], v22 offset:0
    ds_read_b128 v[68:71], v22 offset:1024
    v_cvt_pk_bf16_f32 v52, v32, v33
    v_mfma_f32_16x16x32_bf16 v[40:43], a[168:171], a[152:155], v[40:43]
    v_exp_f32 v34, v34
    v_mfma_f32_16x16x32_bf16 v[144:147], a[200:203], v[48:51], v[144:147]
    ds_read_b128 v[72:75], v22 offset:2048
    ds_read_b128 v[76:79], v22 offset:3072
    v_mov_b32 v7, 65536
    v_mfma_f32_16x16x32_bf16 v[40:43], a[172:175], a[156:159], v[40:43]
    v_exp_f32 v35, v35
    v_mfma_f32_16x16x32_bf16 v[148:151], a[204:207], v[48:51], v[148:151]
    ds_write_b128 v21, a[16:19] offset:4096
    v_cvt_pk_bf16_f32 v53, v34, v35
    s_waitcnt lgkmcnt(5)
    v_add_f32 v196, v196, v197
    v_rcp_f32 v196, v196
    v_mfma_f32_16x16x32_bf16 v[44:47], a[176:179], a[144:147], v[212:215]
    v_exp_f32 v36, v36
    v_mfma_f32_16x16x32_bf16 a[32:35], a[208:211], v[48:51], a[32:35]
    ds_write_b128 v21, a[20:23] offset:5120
    s_waitcnt lgkmcnt(5)
    v_add_f32 v104, v104, v64
    v_add_f32 v105, v105, v65
    v_add_f32 v106, v106, v66
    v_add_f32 v107, v107, v67
    s_waitcnt lgkmcnt(4)
    v_add_f32 v108, v108, v68
    v_mfma_f32_16x16x32_bf16 v[44:47], a[180:183], a[148:151], v[44:47]
    v_exp_f32 v37, v37
    v_mfma_f32_16x16x32_bf16 a[36:39], a[212:215], v[48:51], a[36:39]
    ds_write_b128 v21, a[24:27] offset:6144
    v_cvt_pk_bf16_f32 v54, v36, v37
    v_add_f32 v109, v109, v69
    v_add_f32 v110, v110, v70
    v_add_f32 v111, v111, v71
    v_mul_f32 v104, v196, v104
    v_mul_f32 v105, v196, v105
    v_mfma_f32_16x16x32_bf16 v[44:47], a[184:187], a[152:155], v[44:47]
    v_exp_f32 v38, v38
    v_mfma_f32_16x16x32_bf16 a[40:43], a[216:219], v[48:51], a[40:43]
    ds_write_b128 v21, a[28:31] offset:7168
    v_mul_f32 v106, v196, v106
    v_mul_f32 v107, v196, v107
    v_mul_f32 v108, v196, v108
    v_mul_f32 v109, v196, v109
    v_mul_f32 v110, v196, v110
    v_mfma_f32_16x16x32_bf16 v[44:47], a[188:191], a[156:159], v[44:47]
    v_exp_f32 v39, v39
    v_mfma_f32_16x16x32_bf16 a[44:47], a[220:223], v[48:51], a[44:47]
    ds_write_b32 v3, v220 offset:16640
    v_cvt_pk_bf16_f32 v55, v38, v39
    v_mul_f32 v111, v196, v111
    v_cvt_pk_bf16_f32 v104, v104, v105
    v_cvt_pk_bf16_f32 v105, v106, v107
    v_cvt_pk_bf16_f32 v106, v108, v109
    v_cvt_pk_bf16_f32 v107, v110, v111
    v_mfma_f32_16x16x32_bf16 v[224:227], a[224:227], v[48:51], v[224:227]
    buffer_store_dwordx4 v[104:107], v20, s[20:23], s50 offen offset:0 sc0 sc1
    ds_write_b128 v2, v[104:107] offset:0
    s_waitcnt lgkmcnt(7)
    v_add_f32 v112, v112, v72
    v_add_f32 v113, v113, v73
    v_add_f32 v114, v114, v74
    v_add_f32 v115, v115, v75
    s_waitcnt lgkmcnt(6)
    v_add_f32 v116, v116, v76
    v_add_f32 v117, v117, v77
    v_add_f32 v118, v118, v78
    v_add_f32 v119, v119, v79
    v_mul_f32 v112, v196, v112
    v_mul_f32 v113, v196, v113
    v_mul_f32 v114, v196, v114
    v_mul_f32 v115, v196, v115
    v_mul_f32 v116, v196, v116
    v_mul_f32 v117, v196, v117
    v_mul_f32 v118, v196, v118
    v_mul_f32 v119, v196, v119
    v_cvt_pk_bf16_f32 v112, v112, v113
    v_cvt_pk_bf16_f32 v113, v114, v115
    v_cvt_pk_bf16_f32 v114, v116, v117
    v_cvt_pk_bf16_f32 v115, v118, v119
    s_waitcnt lgkmcnt(1)
    s_barrier
    v_exp_f32 v40, v40
    v_mfma_f32_16x16x32_bf16 v[152:155], a[192:195], v[52:55], v[152:155]
    ds_read_b32 v198, v4 offset:16640
    ds_read_b32 v199, v5 offset:16640
    buffer_store_dwordx4 v[112:115], v20, s[20:23], s51 offen offset:0 sc0 sc1
    v_exp_f32 v41, v41
    v_mfma_f32_16x16x32_bf16 v[156:159], a[196:199], v[52:55], v[156:159]
    ds_read_b128 v[80:83], v22 offset:4096
    ds_read_b128 v[84:87], v22 offset:5120
    v_cvt_pk_bf16_f32 v56, v40, v41
    v_exp_f32 v42, v42
    v_mfma_f32_16x16x32_bf16 v[160:163], a[200:203], v[52:55], v[160:163]
    ds_read_b128 v[88:91], v22 offset:6144
    ds_read_b128 v[92:95], v22 offset:7168
    v_exp_f32 v43, v43
    v_mfma_f32_16x16x32_bf16 v[164:167], a[204:207], v[52:55], v[164:167]
    ds_write_b128 v21, a[32:35] offset:8192
    v_cvt_pk_bf16_f32 v57, v42, v43
    s_waitcnt lgkmcnt(5)
    v_add_f32 v198, v198, v199
    v_rcp_f32 v198, v198
    v_exp_f32 v44, v44
    v_mfma_f32_16x16x32_bf16 a[48:51], a[208:211], v[52:55], a[48:51]
    ds_write_b128 v21, a[36:39] offset:9216
    s_waitcnt lgkmcnt(5)
    v_add_f32 v120, v120, v80
    v_add_f32 v121, v121, v81
    v_add_f32 v122, v122, v82
    v_add_f32 v123, v123, v83
    s_waitcnt lgkmcnt(4)
    v_add_f32 v124, v124, v84
    v_exp_f32 v45, v45
    v_mfma_f32_16x16x32_bf16 a[52:55], a[212:215], v[52:55], a[52:55]
    ds_write_b128 v21, a[40:43] offset:10240
    v_cvt_pk_bf16_f32 v58, v44, v45
    v_add_f32 v125, v125, v85
    v_add_f32 v126, v126, v86
    v_add_f32 v127, v127, v87
    v_mul_f32 v120, v198, v120
    v_mul_f32 v121, v198, v121
    v_exp_f32 v46, v46
    v_mfma_f32_16x16x32_bf16 a[56:59], a[216:219], v[52:55], a[56:59]
    ds_write_b128 v21, a[44:47] offset:11264
    v_mul_f32 v122, v198, v122
    v_mul_f32 v123, v198, v123
    v_mul_f32 v124, v198, v124
    v_mul_f32 v125, v198, v125
    v_mul_f32 v126, v198, v126
    v_exp_f32 v47, v47
    v_mfma_f32_16x16x32_bf16 a[60:63], a[220:223], v[52:55], a[60:63]
    ds_write_b128 v2, v[112:115] offset:10240
    ds_write_b32 v3, v224 offset:16896
    v_cvt_pk_bf16_f32 v59, v46, v47
    v_mul_f32 v127, v198, v127
    v_cvt_pk_bf16_f32 v120, v120, v121
    v_cvt_pk_bf16_f32 v121, v122, v123
    v_cvt_pk_bf16_f32 v122, v124, v125
    v_cvt_pk_bf16_f32 v123, v126, v127
    v_mfma_f32_16x16x32_bf16 v[228:231], a[224:227], v[52:55], v[228:231]
    buffer_store_dwordx4 v[120:123], v20, s[20:23], s50 offen offset:1024 sc0 sc1
    ds_write_b128 v2, v[120:123] offset:1024
    s_waitcnt lgkmcnt(8)
    v_pk_add_f32 v[128:129], v[128:129], v[88:89]
    v_pk_add_f32 v[130:131], v[130:131], v[90:91]
    s_waitcnt lgkmcnt(7)
    v_pk_add_f32 v[132:133], v[132:133], v[92:93]
    v_pk_add_f32 v[134:135], v[134:135], v[94:95]
    v_pk_mul_f32 v[128:129], v[128:129], v[198:199] op_sel_hi:[1,0]
    v_pk_mul_f32 v[130:131], v[130:131], v[198:199] op_sel_hi:[1,0]
    v_pk_mul_f32 v[132:133], v[132:133], v[198:199] op_sel_hi:[1,0]
    v_pk_mul_f32 v[134:135], v[134:135], v[198:199] op_sel_hi:[1,0]
    v_cvt_pk_bf16_f32 v128, v128, v129
    v_cvt_pk_bf16_f32 v129, v130, v131
    v_cvt_pk_bf16_f32 v130, v132, v133
    v_cvt_pk_bf16_f32 v131, v134, v135
    s_waitcnt lgkmcnt(1)
    s_barrier
    v_mfma_f32_16x16x32_bf16 v[168:171], a[192:195], v[56:59], v[168:171]
    ds_read_b32 v200, v4 offset:16896
    ds_read_b32 v201, v5 offset:16896
    buffer_store_dwordx4 v[128:131], v20, s[20:23], s51 offen offset:1024 sc0 sc1
    v_mfma_f32_16x16x32_bf16 v[172:175], a[196:199], v[56:59], v[172:175]
    ds_read_b128 v[64:67], v22 offset:8192
    ds_read_b128 v[68:71], v22 offset:9216
    v_mfma_f32_16x16x32_bf16 v[176:179], a[200:203], v[56:59], v[176:179]
    ds_read_b128 v[72:75], v22 offset:10240
    ds_read_b128 v[76:79], v22 offset:11264
    v_mfma_f32_16x16x32_bf16 v[180:183], a[204:207], v[56:59], v[180:183]
    ds_write_b128 v21, a[48:51] offset:12288
    v_mfma_f32_16x16x32_bf16 a[64:67], a[208:211], v[56:59], a[64:67]
    ds_write_b128 v21, a[52:55] offset:13312
    v_mfma_f32_16x16x32_bf16 a[68:71], a[212:215], v[56:59], a[68:71]
    ds_write_b128 v21, a[56:59] offset:14336
    v_mfma_f32_16x16x32_bf16 a[72:75], a[216:219], v[56:59], a[72:75]
    ds_write_b128 v21, a[60:63] offset:15360
    s_waitcnt lgkmcnt(8)
    v_add_f32 v200, v200, v201
    v_rcp_f32 v200, v200
    v_mfma_f32_16x16x32_bf16 a[76:79], a[220:223], v[56:59], a[76:79]
    ds_write_b128 v2, v[128:131] offset:11264
    ds_write_b32 v3, v228 offset:17152
    v_mfma_f32_16x16x32_bf16 v[232:235], a[224:227], v[56:59], v[232:235]
    s_waitcnt lgkmcnt(9)
    v_pk_add_f32 v[136:137], v[136:137], v[64:65]
    v_pk_add_f32 v[138:139], v[138:139], v[66:67]
    s_waitcnt lgkmcnt(8)
    v_pk_add_f32 v[140:141], v[140:141], v[68:69]
    v_pk_add_f32 v[142:143], v[142:143], v[70:71]
    v_pk_mul_f32 v[136:137], v[136:137], v[200:201] op_sel_hi:[1,0]
    v_pk_mul_f32 v[138:139], v[138:139], v[200:201] op_sel_hi:[1,0]
    v_pk_mul_f32 v[140:141], v[140:141], v[200:201] op_sel_hi:[1,0]
    v_pk_mul_f32 v[142:143], v[142:143], v[200:201] op_sel_hi:[1,0]
    v_cvt_pk_bf16_f32 v136, v136, v137
    v_cvt_pk_bf16_f32 v137, v138, v139
    v_cvt_pk_bf16_f32 v138, v140, v141
    v_cvt_pk_bf16_f32 v139, v142, v143
    ds_write_b128 v21, a[64:67] offset:16384
    ds_write_b128 v21, a[68:71] offset:17408
    ds_write_b128 v21, a[72:75] offset:18432
    ds_write_b128 v21, a[76:79] offset:19456
    ds_write_b32 v3, v232 offset:17408
    buffer_store_dwordx4 v[136:139], v20, s[20:23], s50 offen offset:2048 sc0 sc1
    v_add_f32 v8, v216, v220
    v_add_f32 v9, v224, v228
    v_add_f32 v8, v8, v232
    v_add_f32 v8, v8, v9
    v_cmp_nge_f32 vcc, 0x53800000, v8
    s_nop 0
    s_cmp_lg_u64 vcc, 0
    s_cselect_b32 s41, 1, 0
    v_mov_b32 v8, s41
    ds_write_b32 v6, v8 offset:21504
    s_waitcnt lgkmcnt(13)
    v_pk_add_f32 v[144:145], v[144:145], v[72:73]
    v_pk_add_f32 v[146:147], v[146:147], v[74:75]
    s_waitcnt lgkmcnt(12)
    v_pk_add_f32 v[148:149], v[148:149], v[76:77]
    v_pk_add_f32 v[150:151], v[150:151], v[78:79]
    v_pk_mul_f32 v[144:145], v[144:145], v[200:201] op_sel_hi:[1,0]
    v_pk_mul_f32 v[146:147], v[146:147], v[200:201] op_sel_hi:[1,0]
    v_pk_mul_f32 v[148:149], v[148:149], v[200:201] op_sel_hi:[1,0]
    v_pk_mul_f32 v[150:151], v[150:151], v[200:201] op_sel_hi:[1,0]
    v_cvt_pk_bf16_f32 v144, v144, v145
    v_cvt_pk_bf16_f32 v145, v146, v147
    v_cvt_pk_bf16_f32 v146, v148, v149
    v_cvt_pk_bf16_f32 v147, v150, v151
    buffer_store_dwordx4 v[144:147], v20, s[20:23], s51 offen offset:2048 sc0 sc1
    s_waitcnt lgkmcnt(0)
    s_barrier
    ds_read_b128 v[208:211], v7 offset:21504
    ds_read_b32 v202, v4 offset:17152
    ds_read_b32 v203, v5 offset:17152
    ds_read_b32 v204, v4 offset:17408
    ds_read_b32 v205, v5 offset:17408
    ds_read_b128 v[80:83], v22 offset:12288
    ds_read_b128 v[84:87], v22 offset:13312
    ds_read_b128 v[88:91], v22 offset:14336
    ds_read_b128 v[92:95], v22 offset:15360
    ds_read_b128 v[24:27], v22 offset:16384
    ds_read_b128 v[28:31], v22 offset:17408
    ds_read_b128 v[32:35], v22 offset:18432
    ds_read_b128 v[36:39], v22 offset:19456
    ds_write_b128 v2, v[136:139] offset:2048
    ds_write_b128 v2, v[144:147] offset:12288
    s_waitcnt lgkmcnt(14)
    v_or_b32 v208, v208, v209
    v_or3_b32 v208, v208, v210, v211
    s_waitcnt lgkmcnt(12)
    v_add_f32 v202, v202, v203
    v_rcp_f32 v202, v202
    s_waitcnt lgkmcnt(10)
    v_add_f32 v204, v204, v205
    v_rcp_f32 v204, v204
    v_readfirstlane_b32 s41, v208
    s_nop 0
    s_andn2_b32 s41, s41, s49
    s_cmp_lg_u32 s41, 0
    s_cbranch_scc1 L_slow
    s_waitcnt lgkmcnt(9)
    v_pk_add_f32 v[152:153], v[152:153], v[80:81]
    v_pk_add_f32 v[154:155], v[154:155], v[82:83]
    s_waitcnt lgkmcnt(8)
    v_pk_add_f32 v[156:157], v[156:157], v[84:85]
    v_pk_add_f32 v[158:159], v[158:159], v[86:87]
    v_pk_mul_f32 v[152:153], v[152:153], v[202:203] op_sel_hi:[1,0]
    v_pk_mul_f32 v[154:155], v[154:155], v[202:203] op_sel_hi:[1,0]
    v_pk_mul_f32 v[156:157], v[156:157], v[202:203] op_sel_hi:[1,0]
    v_pk_mul_f32 v[158:159], v[158:159], v[202:203] op_sel_hi:[1,0]
    v_cvt_pk_bf16_f32 v152, v152, v153
    v_cvt_pk_bf16_f32 v153, v154, v155
    v_cvt_pk_bf16_f32 v154, v156, v157
    v_cvt_pk_bf16_f32 v155, v158, v159
    buffer_store_dwordx4 v[152:155], v20, s[20:23], s50 offen offset:3072 sc0 sc1
    ds_write_b128 v2, v[152:155] offset:3072
    s_waitcnt lgkmcnt(8)
    v_pk_add_f32 v[160:161], v[160:161], v[88:89]
    v_pk_add_f32 v[162:163], v[162:163], v[90:91]
    s_waitcnt lgkmcnt(7)
    v_pk_add_f32 v[164:165], v[164:165], v[92:93]
    v_pk_add_f32 v[166:167], v[166:167], v[94:95]
    v_pk_mul_f32 v[160:161], v[160:161], v[202:203] op_sel_hi:[1,0]
    v_pk_mul_f32 v[162:163], v[162:163], v[202:203] op_sel_hi:[1,0]
    v_pk_mul_f32 v[164:165], v[164:165], v[202:203] op_sel_hi:[1,0]
    v_pk_mul_f32 v[166:167], v[166:167], v[202:203] op_sel_hi:[1,0]
    v_cvt_pk_bf16_f32 v160, v160, v161
    v_cvt_pk_bf16_f32 v161, v162, v163
    v_cvt_pk_bf16_f32 v162, v164, v165
    v_cvt_pk_bf16_f32 v163, v166, v167
    buffer_store_dwordx4 v[160:163], v20, s[20:23], s51 offen offset:3072 sc0 sc1
    ds_write_b128 v2, v[160:163] offset:13312
    s_waitcnt lgkmcnt(7)
    v_pk_add_f32 v[168:169], v[168:169], v[24:25]
    v_pk_add_f32 v[170:171], v[170:171], v[26:27]
    s_waitcnt lgkmcnt(6)
    v_pk_add_f32 v[172:173], v[172:173], v[28:29]
    v_pk_add_f32 v[174:175], v[174:175], v[30:31]
    v_pk_mul_f32 v[168:169], v[168:169], v[204:205] op_sel_hi:[1,0]
    v_pk_mul_f32 v[170:171], v[170:171], v[204:205] op_sel_hi:[1,0]
    v_pk_mul_f32 v[172:173], v[172:173], v[204:205] op_sel_hi:[1,0]
    v_pk_mul_f32 v[174:175], v[174:175], v[204:205] op_sel_hi:[1,0]
    v_cvt_pk_bf16_f32 v168, v168, v169
    v_cvt_pk_bf16_f32 v169, v170, v171
    v_cvt_pk_bf16_f32 v170, v172, v173
    v_cvt_pk_bf16_f32 v171, v174, v175
    buffer_store_dwordx4 v[168:171], v236, s[20:23], s50 offen offset:0 sc0 sc1
    ds_write_b128 v2, v[168:171] offset:4096
    s_waitcnt lgkmcnt(6)
    v_pk_add_f32 v[176:177], v[176:177], v[32:33]
    v_pk_add_f32 v[178:179], v[178:179], v[34:35]
    s_waitcnt lgkmcnt(5)
    v_pk_add_f32 v[180:181], v[180:181], v[36:37]
    v_pk_add_f32 v[182:183], v[182:183], v[38:39]
    v_pk_mul_f32 v[176:177], v[176:177], v[204:205] op_sel_hi:[1,0]
    v_pk_mul_f32 v[178:179], v[178:179], v[204:205] op_sel_hi:[1,0]
    v_pk_mul_f32 v[180:181], v[180:181], v[204:205] op_sel_hi:[1,0]
    v_pk_mul_f32 v[182:183], v[182:183], v[204:205] op_sel_hi:[1,0]
    v_cvt_pk_bf16_f32 v176, v176, v177
    v_cvt_pk_bf16_f32 v177, v178, v179
    v_cvt_pk_bf16_f32 v178, v180, v181
    v_cvt_pk_bf16_f32 v179, v182, v183
    buffer_store_dwordx4 v[176:179], v236, s[20:23], s51 offen offset:0 sc0 sc1
    ds_write_b128 v2, v[176:179] offset:14336
    s_mov_b32 s32, 90112
    s_mov_b32 s31, 0
    s_mov_b32 s33, 53248
    s_mov_b32 s90, 0
    s_mov_b32 s63, s28
    v_and_b32 v21, 7, v1
    v_lshlrev_b32 v21, 8, v21
    v_and_b32 v4, 3, v1
    v_mul_u32_u24 v4, 256, v4
    v_lshrrev_b32 v5, 1, v20
    s_waitcnt vmcnt(10) lgkmcnt(0)
    s_barrier
    ds_read_b64_tr_b16 a[84:85], v245 offset:0
    ds_read_b64_tr_b16 a[86:87], v245 offset:4096
    ds_read_b64_tr_b16 a[100:101], v245 offset:8192
    ds_read_b64_tr_b16 a[102:103], v245 offset:12288
    ds_read_b128 a[132:135], v239 offset:0
    ds_read_b128 a[112:115], v238 offset:0
    ds_read_b128 a[116:119], v238 offset:1024
    ds_read_b128 a[136:139], v239 offset:1024
    ds_read_b128 a[140:143], v239 offset:2048
    ds_read_b128 a[120:123], v238 offset:2048
    ds_read_b128 a[124:127], v238 offset:3072
    ds_read_b128 a[144:147], v239 offset:3072
    ds_read_b128 a[148:151], v239 offset:4096
    ds_read_b128 a[128:131], v238 offset:4096
    ds_read_b64_tr_b16 a[88:89], v246 offset:0
    ds_read_b64_tr_b16 a[90:91], v246 offset:4096
    ds_read_b64_tr_b16 a[104:105], v246 offset:8192
    ds_read_b64_tr_b16 a[106:107], v246 offset:12288
    v_mfma_f32_32x32x16_bf16 v[24:39], v[240:243], v[240:243], 0
    v_mfma_f32_16x16x32_bf16 v[40:43], v[240:243], v[240:243], 0
    v_mfma_f32_32x32x16_bf16 v[84:99], v[240:243], v[240:243], 0
    v_mfma_f32_16x16x32_bf16 v[100:103], v[240:243], v[240:243], 0
    s_and_b32 s41, s80, 15
    s_lshl_b32 s37, s41, 17
    s_add_u32 s38, s33, s44
    s_add_u32 m0, s38, 20480
    s_add_u32 s42, s32, 36864
    s_cmp_ge_u32 s42, 163840
    s_cselect_b32 s42, 53248, s42
    s_sub_u32 s34, s42, s32
    buffer_load_dwordx4 v248, s[76:79], s37 offen offset:0 lds
    buffer_load_dwordx4 v249, s[76:79], s37 offen offset:1024 lds
    s_mul_i32 s36, s41, 20480
    s_lshr_b32 s43, s41, 1
    s_lshr_b64 s[80:81], s[80:81], 4
    s_add_u32 s39, s33, s40
    s_mov_b32 s33, s32
    s_mov_b32 s32, s42
    s_add_u32 s31, s31, 1
    s_waitcnt lgkmcnt(12)
    v_mfma_f32_16x16x32_bf16 v[44:47], a[84:87], a[112:115], 0
    buffer_load_dwordx4 v250, s[76:79], s37 offen offset:2048 lds
    v_mfma_f32_16x16x32_bf16 v[44:47], a[100:103], a[132:135], v[44:47]
    ds_read_b64_tr_b16 a[92:93], v247 offset:0
    s_waitcnt lgkmcnt(11)
    v_mfma_f32_16x16x32_bf16 v[48:51], a[100:103], a[136:139], 0
    buffer_load_dwordx4 v251, s[76:79], s37 offen offset:3072 lds
    v_mfma_f32_16x16x32_bf16 v[48:51], a[84:87], a[116:119], v[48:51]
    ds_read_b64_tr_b16 a[94:95], v247 offset:4096
    s_waitcnt lgkmcnt(10)
    v_mfma_f32_16x16x32_bf16 v[52:55], a[84:87], a[120:123], 0
    v_add_u32 v245, s34, v245
    v_add_u32 v246, s34, v246
    v_add_u32 v238, s34, v238
    v_mfma_f32_16x16x32_bf16 v[52:55], a[100:103], a[140:143], v[52:55]
    ds_read_b64_tr_b16 a[108:109], v247 offset:8192
    s_waitcnt lgkmcnt(9)
    v_mfma_f32_16x16x32_bf16 v[56:59], a[100:103], a[144:147], 0
    v_add_u32 v239, s34, v239
    v_mfma_f32_16x16x32_bf16 v[56:59], a[84:87], a[124:127], v[56:59]
    ds_read_b64_tr_b16 a[110:111], v247 offset:12288
    s_waitcnt lgkmcnt(8)
    v_mfma_f32_16x16x32_bf16 v[60:63], a[84:87], a[128:131], 0
    v_add_u32 v247, s34, v247
    s_waitcnt lgkmcnt(4)
    v_mfma_f32_16x16x32_bf16 v[60:63], a[100:103], a[148:151], v[60:63]
    ds_read_b64_tr_b16 a[80:81], v244 offset:0
    v_mfma_f32_16x16x32_bf16 v[80:83], a[104:107], a[148:151], 0
    v_mfma_f32_16x16x32_bf16 v[80:83], a[88:91], a[128:131], v[80:83]
    ds_read_b64_tr_b16 a[82:83], v244 offset:4096
    v_mfma_f32_16x16x32_bf16 v[76:79], a[88:91], a[124:127], 0
    v_mfma_f32_16x16x32_bf16 v[76:79], a[104:107], a[144:147], v[76:79]
    ds_read_b64_tr_b16 a[96:97], v244 offset:8192
    v_mfma_f32_16x16x32_bf16 v[72:75], a[104:107], a[140:143], 0
    v_mfma_f32_16x16x32_bf16 v[72:75], a[88:91], a[120:123], v[72:75]
    ds_read_b64_tr_b16 a[98:99], v244 offset:12288
    v_add_u32 v244, s34, v244
    v_mfma_f32_16x16x32_bf16 v[68:71], a[88:91], a[116:119], 0
    v_mfma_f32_16x16x32_bf16 v[68:71], a[104:107], a[136:139], v[68:71]
    v_mfma_f32_16x16x32_bf16 v[64:67], a[104:107], a[132:135], 0
    v_mfma_f32_16x16x32_bf16 v[64:67], a[88:91], a[112:115], v[64:67]
    buffer_load_dwordx2 v[22:23], v21, s[20:23], s88 offen offset:2048 sc1
    s_mov_b32 s54, 0
    s_waitcnt vmcnt(5) lgkmcnt(0)
    s_branch L_non1
L_non:
    s_waitcnt vmcnt(0)
L_non1:
    v_readfirstlane_b32 s64, v18
    v_readfirstlane_b32 s65, v19
    s_cmp_lg_u32 s64, 0
    s_cbranch_scc1 L_nonok
    buffer_load_dwordx2 v[18:19], v240, s[24:27], 0 offen sc0 sc1
    s_add_u32 s54, s54, 1
    s_cmp_lt_u32 s54, 100000
    s_cbranch_scc1 L_non
L_nonok:
    s_barrier
    s_cmp_lg_u32 s28, 0
    s_cbranch_scc1 L_pubd
    s_lshl_b32 s41, s61, 8
    s_add_u32 s41, s41, s88
    s_mov_b64 exec, 1
    buffer_store_dwordx2 v[18:19], v240, s[20:23], s41 offen offset:2048
    buffer_store_dwordx2 v[18:19], v240, s[20:23], s41 offen sc0 sc1
    s_mov_b64 exec, -1
    s_waitcnt vmcnt(2)
    s_branch L_pubd1
L_pubd:
    s_waitcnt vmcnt(0)
L_pubd1:
    v_cmp_eq_u64 s[92:93], s[64:65], v[22:23]
    s_nop 0
    s_or_b32 s90, s90, s92
    s_bitcmp1_b32 s90, s43
    s_cbranch_scc1 L_poll0ok
    s_mov_b32 s54, 0
L_poll0:
    buffer_load_dwordx2 v[22:23], v21, s[20:23], s88 offen offset:2048 sc1
    s_waitcnt vmcnt(0)
    v_cmp_eq_u64 s[92:93], s[64:65], v[22:23]
    s_nop 0
    s_or_b32 s90, s90, s92
    s_bitcmp1_b32 s90, s43
    s_cbranch_scc1 L_poll0ok
    s_sleep 2
    buffer_load_dwordx2 v[22:23], v21, s[20:23], s88 offen offset:2048 sc1
    s_waitcnt vmcnt(0)
    v_cmp_eq_u64 s[92:93], s[64:65], v[22:23]
    s_nop 0
    s_or_b32 s90, s90, s92
    s_bitcmp1_b32 s90, s43
    s_cbranch_scc1 L_poll0ok
    s_sleep 2
    buffer_load_dwordx2 v[22:23], v21, s[20:23], s88 offen offset:2048 sc1
    s_waitcnt vmcnt(0)
    v_cmp_eq_u64 s[92:93], s[64:65], v[22:23]
    s_nop 0
    s_or_b32 s90, s90, s92
    s_bitcmp1_b32 s90, s43
    s_cbranch_scc1 L_poll0ok
    s_sleep 2
    buffer_load_dwordx2 v[22:23], v21, s[20:23], s88 offen offset:2048 sc1
    s_waitcnt vmcnt(0)
    v_cmp_eq_u64 s[92:93], s[64:65], v[22:23]
    s_nop 0
    s_or_b32 s90, s90, s92
    s_bitcmp1_b32 s90, s43
    s_cbranch_scc1 L_poll0ok
    s_sleep 2
    buffer_load_dwordx2 v[22:23], v21, s[20:23], s88 offen offset:2048 sc1
    s_waitcnt vmcnt(0)
    v_cmp_eq_u64 s[92:93], s[64:65], v[22:23]
    s_nop 0
    s_or_b32 s90, s90, s92
    s_bitcmp1_b32 s90, s43
    s_cbranch_scc1 L_poll0ok
    s_sleep 2
    buffer_load_dwordx2 v[22:23], v21, s[20:23], s88 offen offset:2048 sc1
    s_waitcnt vmcnt(0)
    v_cmp_eq_u64 s[92:93], s[64:65], v[22:23]
    s_nop 0
    s_or_b32 s90, s90, s92
    s_bitcmp1_b32 s90, s43
    s_cbranch_scc1 L_poll0ok
    s_sleep 2
    buffer_load_dwordx2 v[22:23], v21, s[20:23], s88 offen sc0 sc1
    s_waitcnt vmcnt(0)
    v_cmp_eq_u64 s[92:93], s[64:65], v[22:23]
    s_nop 0
    s_or_b32 s90, s90, s92
    s_bitcmp1_b32 s90, s43
    s_cbranch_scc1 L_poll0ok
    s_add_u32 s54, s54, 1
    s_cmp_lt_u32 s54, 100000
    s_cbranch_scc1 L_poll0
L_poll0ok:
    s_mov_b32 m0, s38
    s_and_b32 s41, s80, 15
    buffer_load_dwordx4 v252, s[72:75], s36 offen offset:0 sc0 sc1 lds
    buffer_load_dwordx4 v252, s[72:75], s36 offen offset:1024 sc0 sc1 lds
    buffer_load_dwordx4 v252, s[72:75], s36 offen offset:2048 sc0 sc1 lds
    buffer_load_dwordx4 v252, s[72:75], s36 offen offset:3072 sc0 sc1 lds
    s_mov_b32 m0, s39
    s_lshl_b32 s37, s41, 17
    buffer_load_dwordx4 v253, s[72:75], s36 offen sc0 sc1 lds
.p2align 3
L_p3:
    s_barrier
    v_mfma_f32_16x16x32_bf16 v[84:87], a[92:95], a[112:115], v[84:87]
    ds_read_b64_tr_b16 a[84:85], v245 offset:0
    s_and_b32 s41, s80, 15
    v_mfma_f32_16x16x32_bf16 v[84:87], a[108:111], a[132:135], v[84:87]
    ds_read_b64_tr_b16 a[86:87], v245 offset:4096
    s_lshl_b32 s37, s41, 17
    v_mfma_f32_16x16x32_bf16 v[88:91], a[108:111], a[136:139], v[88:91]
    ds_read_b64_tr_b16 a[100:101], v245 offset:8192
    s_add_u32 s38, s33, s44
    v_mfma_f32_16x16x32_bf16 v[88:91], a[92:95], a[116:119], v[88:91]
    ds_read_b64_tr_b16 a[102:103], v245 offset:12288
    s_add_u32 m0, s38, 20480
    v_mfma_f32_16x16x32_bf16 v[92:95], a[92:95], a[120:123], v[92:95]
    buffer_load_dwordx4 v248, s[76:79], s37 offen offset:0 lds
    v_mfma_f32_16x16x32_bf16 v[92:95], a[108:111], a[140:143], v[92:95]
    ds_read_b64_tr_b16 a[88:89], v246 offset:0
    s_add_u32 s42, s32, 36864
    v_mfma_f32_16x16x32_bf16 v[96:99], a[108:111], a[144:147], v[96:99]
    ds_read_b64_tr_b16 a[90:91], v246 offset:4096
    s_cmp_ge_u32 s42, 163840
    v_mfma_f32_16x16x32_bf16 v[96:99], a[92:95], a[124:127], v[96:99]
    ds_read_b64_tr_b16 a[104:105], v246 offset:8192
    s_cselect_b32 s42, 53248, s42
    v_mfma_f32_16x16x32_bf16 v[100:103], a[92:95], a[128:131], v[100:103]
    ds_read_b64_tr_b16 a[106:107], v246 offset:12288
    s_sub_u32 s34, s42, s32
    v_mfma_f32_16x16x32_bf16 v[100:103], a[108:111], a[148:151], v[100:103]
    buffer_load_dwordx4 v249, s[76:79], s37 offen offset:1024 lds
    v_mfma_f32_16x16x32_bf16 v[24:27], a[96:99], a[132:135], v[24:27]
    ds_read_b128 a[132:135], v239 offset:0
    s_mul_i32 s36, s41, 20480
    v_mfma_f32_16x16x32_bf16 v[24:27], a[80:83], a[112:115], v[24:27]
    ds_read_b128 a[112:115], v238 offset:0
    s_lshr_b32 s43, s41, 1
    v_mfma_f32_16x16x32_bf16 v[28:31], a[80:83], a[116:119], v[28:31]
    ds_read_b128 a[116:119], v238 offset:1024
    v_mfma_f32_16x16x32_bf16 v[28:31], a[96:99], a[136:139], v[28:31]
    ds_read_b128 a[136:139], v239 offset:1024
    v_mfma_f32_16x16x32_bf16 v[32:35], a[96:99], a[140:143], v[32:35]
    buffer_load_dwordx4 v250, s[76:79], s37 offen offset:2048 lds
    v_mfma_f32_16x16x32_bf16 v[32:35], a[80:83], a[120:123], v[32:35]
    ds_read_b128 a[140:143], v239 offset:2048
    ds_read_b128 a[120:123], v238 offset:2048
    v_mfma_f32_16x16x32_bf16 v[36:39], a[80:83], a[124:127], v[36:39]
    ds_read_b128 a[124:127], v238 offset:3072
    v_mfma_f32_16x16x32_bf16 v[36:39], a[96:99], a[144:147], v[36:39]
    ds_read_b128 a[144:147], v239 offset:3072
    v_mfma_f32_16x16x32_bf16 v[40:43], a[96:99], a[148:151], v[40:43]
    ds_read_b128 a[148:151], v239 offset:4096
    v_mfma_f32_16x16x32_bf16 v[40:43], a[80:83], a[128:131], v[40:43]
    ds_read_b128 a[128:131], v238 offset:4096
    s_waitcnt lgkmcnt(8)
    v_mfma_f32_16x16x32_bf16 v[44:47], a[84:87], a[112:115], v[44:47]
    buffer_load_dwordx4 v251, s[76:79], s37 offen offset:3072 lds
    v_mfma_f32_16x16x32_bf16 v[44:47], a[100:103], a[132:135], v[44:47]
    ds_read_b64_tr_b16 a[92:93], v247 offset:0
    s_waitcnt lgkmcnt(7)
    v_mfma_f32_16x16x32_bf16 v[48:51], a[100:103], a[136:139], v[48:51]
    s_mov_b32 m0, s38
    s_bitcmp0_b32 s90, s43
    s_cbranch_scc1 L_wait1
L_wait1back:
    v_mfma_f32_16x16x32_bf16 v[48:51], a[84:87], a[116:119], v[48:51]
    ds_read_b64_tr_b16 a[94:95], v247 offset:4096
    s_waitcnt lgkmcnt(6)
    v_mfma_f32_16x16x32_bf16 v[52:55], a[84:87], a[120:123], v[52:55]
    buffer_load_dwordx4 v252, s[72:75], s36 offen offset:0 sc0 sc1 lds
    v_mfma_f32_16x16x32_bf16 v[52:55], a[100:103], a[140:143], v[52:55]
    ds_read_b64_tr_b16 a[108:109], v247 offset:8192
    s_waitcnt lgkmcnt(5)
    v_mfma_f32_16x16x32_bf16 v[56:59], a[100:103], a[144:147], v[56:59]
    s_lshr_b64 s[80:81], s[80:81], 4
    s_add_u32 s39, s33, s40
    s_mov_b32 s33, s32
    v_mfma_f32_16x16x32_bf16 v[56:59], a[84:87], a[124:127], v[56:59]
    ds_read_b64_tr_b16 a[110:111], v247 offset:12288
    s_waitcnt lgkmcnt(4)
    v_mfma_f32_16x16x32_bf16 v[60:63], a[84:87], a[128:131], v[60:63]
    buffer_load_dwordx4 v252, s[72:75], s36 offen offset:1024 sc0 sc1 lds
    v_mfma_f32_16x16x32_bf16 v[60:63], a[100:103], a[148:151], v[60:63]
    ds_read_b64_tr_b16 a[80:81], v244 offset:0
    s_mov_b32 s32, s42
    v_mfma_f32_16x16x32_bf16 v[80:83], a[104:107], a[148:151], v[80:83]
    s_add_u32 s31, s31, 1
    s_cmp_lt_u32 s31, 14
    s_cselect_b64 vcc, -1, 0
    v_mfma_f32_16x16x32_bf16 v[80:83], a[88:91], a[128:131], v[80:83]
    ds_read_b64_tr_b16 a[82:83], v244 offset:4096
    v_add_u32 v245, s34, v245
    v_mfma_f32_16x16x32_bf16 v[76:79], a[88:91], a[124:127], v[76:79]
    buffer_load_dwordx4 v252, s[72:75], s36 offen offset:2048 sc0 sc1 lds
    v_mfma_f32_16x16x32_bf16 v[76:79], a[104:107], a[144:147], v[76:79]
    ds_read_b64_tr_b16 a[96:97], v244 offset:8192
    v_add_u32 v246, s34, v246
    v_mfma_f32_16x16x32_bf16 v[72:75], a[104:107], a[140:143], v[72:75]
    buffer_load_dwordx4 v252, s[72:75], s36 offen offset:3072 sc0 sc1 lds
    v_mfma_f32_16x16x32_bf16 v[72:75], a[88:91], a[120:123], v[72:75]
    ds_read_b64_tr_b16 a[98:99], v244 offset:12288
    s_mov_b32 m0, s39
    v_mfma_f32_16x16x32_bf16 v[68:71], a[88:91], a[116:119], v[68:71]
    v_add_u32 v238, s34, v238
    v_add_u32 v239, s34, v239
    v_add_u32 v247, s34, v247
    v_mfma_f32_16x16x32_bf16 v[68:71], a[104:107], a[136:139], v[68:71]
    v_add_u32 v244, s34, v244
    v_mfma_f32_16x16x32_bf16 v[64:67], a[104:107], a[132:135], v[64:67]
    buffer_load_dwordx4 v253, s[72:75], s36 offen sc0 sc1 lds
    v_mfma_f32_16x16x32_bf16 v[64:67], a[88:91], a[112:115], v[64:67]
    s_waitcnt vmcnt(9) lgkmcnt(0)
    s_cbranch_vccnz L_p3
    s_barrier
    v_mfma_f32_16x16x32_bf16 v[84:87], a[92:95], a[112:115], v[84:87]
    ds_read_b64_tr_b16 a[84:85], v245 offset:0
    s_add_u32 s42, s32, 36864
    v_mfma_f32_16x16x32_bf16 v[84:87], a[108:111], a[132:135], v[84:87]
    ds_read_b64_tr_b16 a[86:87], v245 offset:4096
    s_cmp_ge_u32 s42, 163840
    v_mfma_f32_16x16x32_bf16 v[88:91], a[108:111], a[136:139], v[88:91]
    ds_read_b64_tr_b16 a[100:101], v245 offset:8192
    s_cselect_b32 s42, 53248, s42
    v_mfma_f32_16x16x32_bf16 v[88:91], a[92:95], a[116:119], v[88:91]
    ds_read_b64_tr_b16 a[102:103], v245 offset:12288
    s_sub_u32 s34, s42, s32
    v_mfma_f32_16x16x32_bf16 v[92:95], a[92:95], a[120:123], v[92:95]
    ds_read_b64_tr_b16 a[88:89], v246 offset:0
    v_mfma_f32_16x16x32_bf16 v[92:95], a[108:111], a[140:143], v[92:95]
    ds_read_b64_tr_b16 a[90:91], v246 offset:4096
    v_mfma_f32_16x16x32_bf16 v[96:99], a[108:111], a[144:147], v[96:99]
    ds_read_b64_tr_b16 a[104:105], v246 offset:8192
    v_mfma_f32_16x16x32_bf16 v[96:99], a[92:95], a[124:127], v[96:99]
    ds_read_b64_tr_b16 a[106:107], v246 offset:12288
    v_mfma_f32_16x16x32_bf16 v[100:103], a[92:95], a[128:131], v[100:103]
    v_mfma_f32_16x16x32_bf16 v[100:103], a[108:111], a[148:151], v[100:103]
    v_mfma_f32_16x16x32_bf16 v[24:27], a[96:99], a[132:135], v[24:27]
    ds_read_b128 a[132:135], v239 offset:0
    v_mfma_f32_16x16x32_bf16 v[24:27], a[80:83], a[112:115], v[24:27]
    ds_read_b128 a[112:115], v238 offset:0
    v_mfma_f32_16x16x32_bf16 v[28:31], a[80:83], a[116:119], v[28:31]
    ds_read_b128 a[116:119], v238 offset:1024
    v_mfma_f32_16x16x32_bf16 v[28:31], a[96:99], a[136:139], v[28:31]
    ds_read_b128 a[136:139], v239 offset:1024
    v_mfma_f32_16x16x32_bf16 v[32:35], a[96:99], a[140:143], v[32:35]
    ds_read_b128 a[140:143], v239 offset:2048
    v_mfma_f32_16x16x32_bf16 v[32:35], a[80:83], a[120:123], v[32:35]
    ds_read_b128 a[120:123], v238 offset:2048
    v_mfma_f32_16x16x32_bf16 v[36:39], a[80:83], a[124:127], v[36:39]
    ds_read_b128 a[124:127], v238 offset:3072
    v_mfma_f32_16x16x32_bf16 v[36:39], a[96:99], a[144:147], v[36:39]
    ds_read_b128 a[144:147], v239 offset:3072
    v_mfma_f32_16x16x32_bf16 v[40:43], a[96:99], a[148:151], v[40:43]
    ds_read_b128 a[148:151], v239 offset:4096
    v_mfma_f32_16x16x32_bf16 v[40:43], a[80:83], a[128:131], v[40:43]
    ds_read_b128 a[128:131], v238 offset:4096
    s_waitcnt lgkmcnt(8)
    v_mfma_f32_16x16x32_bf16 v[44:47], a[84:87], a[112:115], v[44:47]
    v_add_u32 v245, s34, v245
    v_add_u32 v246, s34, v246
    v_add_u32 v238, s34, v238
    v_mfma_f32_16x16x32_bf16 v[44:47], a[100:103], a[132:135], v[44:47]
    ds_read_b64_tr_b16 a[92:93], v247 offset:0
    s_waitcnt lgkmcnt(7)
    v_mfma_f32_16x16x32_bf16 v[48:51], a[100:103], a[136:139], v[48:51]
    v_add_u32 v239, s34, v239
    v_mfma_f32_16x16x32_bf16 v[48:51], a[84:87], a[116:119], v[48:51]
    ds_read_b64_tr_b16 a[94:95], v247 offset:4096
    s_waitcnt lgkmcnt(6)
    v_mfma_f32_16x16x32_bf16 v[52:55], a[84:87], a[120:123], v[52:55]
    v_mfma_f32_16x16x32_bf16 v[52:55], a[100:103], a[140:143], v[52:55]
    ds_read_b64_tr_b16 a[108:109], v247 offset:8192
    s_waitcnt lgkmcnt(5)
    v_mfma_f32_16x16x32_bf16 v[56:59], a[100:103], a[144:147], v[56:59]
    v_mfma_f32_16x16x32_bf16 v[56:59], a[84:87], a[124:127], v[56:59]
    ds_read_b64_tr_b16 a[110:111], v247 offset:12288
    s_waitcnt lgkmcnt(4)
    v_mfma_f32_16x16x32_bf16 v[60:63], a[84:87], a[128:131], v[60:63]
    v_add_u32 v247, s34, v247
    v_mfma_f32_16x16x32_bf16 v[60:63], a[100:103], a[148:151], v[60:63]
    ds_read_b64_tr_b16 a[80:81], v244 offset:0
    v_mfma_f32_16x16x32_bf16 v[80:83], a[104:107], a[148:151], v[80:83]
    v_mfma_f32_16x16x32_bf16 v[80:83], a[88:91], a[128:131], v[80:83]
    ds_read_b64_tr_b16 a[82:83], v244 offset:4096
    v_mfma_f32_16x16x32_bf16 v[76:79], a[88:91], a[124:127], v[76:79]
    v_mfma_f32_16x16x32_bf16 v[76:79], a[104:107], a[144:147], v[76:79]
    ds_read_b64_tr_b16 a[96:97], v244 offset:8192
    v_mfma_f32_16x16x32_bf16 v[72:75], a[104:107], a[140:143], v[72:75]
    v_mfma_f32_16x16x32_bf16 v[72:75], a[88:91], a[120:123], v[72:75]
    ds_read_b64_tr_b16 a[98:99], v244 offset:12288
    v_add_u32 v244, s34, v244
    v_mfma_f32_16x16x32_bf16 v[68:71], a[88:91], a[116:119], v[68:71]
    v_mfma_f32_16x16x32_bf16 v[68:71], a[104:107], a[136:139], v[68:71]
    v_mfma_f32_16x16x32_bf16 v[64:67], a[104:107], a[132:135], v[64:67]
    v_mfma_f32_16x16x32_bf16 v[64:67], a[88:91], a[112:115], v[64:67]
    s_waitcnt vmcnt(0) lgkmcnt(0)
    s_barrier
    v_mfma_f32_16x16x32_bf16 v[84:87], a[92:95], a[112:115], v[84:87]
    ds_read_b64_tr_b16 a[84:85], v245 offset:0
    s_lshl_b32 s41, s62, 8
    v_mfma_f32_16x16x32_bf16 v[84:87], a[108:111], a[132:135], v[84:87]
    ds_read_b64_tr_b16 a[86:87], v245 offset:4096
    s_add_u32 s41, s41, s91
    v_mfma_f32_16x16x32_bf16 v[88:91], a[108:111], a[136:139], v[88:91]
    ds_read_b64_tr_b16 a[100:101], v245 offset:8192
    v_mfma_f32_16x16x32_bf16 v[88:91], a[92:95], a[116:119], v[88:91]
    ds_read_b64_tr_b16 a[102:103], v245 offset:12288
    v_mfma_f32_16x16x32_bf16 v[92:95], a[92:95], a[120:123], v[92:95]
    ds_read_b64_tr_b16 a[88:89], v246 offset:0
    v_mfma_f32_16x16x32_bf16 v[92:95], a[108:111], a[140:143], v[92:95]
    ds_read_b64_tr_b16 a[90:91], v246 offset:4096
    v_mfma_f32_16x16x32_bf16 v[96:99], a[108:111], a[144:147], v[96:99]
    ds_read_b64_tr_b16 a[104:105], v246 offset:8192
    v_mfma_f32_16x16x32_bf16 v[96:99], a[92:95], a[124:127], v[96:99]
    ds_read_b64_tr_b16 a[106:107], v246 offset:12288
    v_mfma_f32_16x16x32_bf16 v[100:103], a[92:95], a[128:131], v[100:103]
    v_mfma_f32_16x16x32_bf16 v[100:103], a[108:111], a[148:151], v[100:103]
    v_mfma_f32_16x16x32_bf16 v[24:27], a[96:99], a[132:135], v[24:27]
    ds_read_b128 a[132:135], v239 offset:0
    v_mfma_f32_16x16x32_bf16 v[24:27], a[80:83], a[112:115], v[24:27]
    ds_read_b128 a[112:115], v238 offset:0
    v_mfma_f32_16x16x32_bf16 v[28:31], a[80:83], a[116:119], v[28:31]
    ds_read_b128 a[116:119], v238 offset:1024
    v_mfma_f32_16x16x32_bf16 v[28:31], a[96:99], a[136:139], v[28:31]
    ds_read_b128 a[136:139], v239 offset:1024
    v_mfma_f32_16x16x32_bf16 v[32:35], a[96:99], a[140:143], v[32:35]
    ds_read_b128 a[140:143], v239 offset:2048
    v_mfma_f32_16x16x32_bf16 v[32:35], a[80:83], a[120:123], v[32:35]
    ds_read_b128 a[120:123], v238 offset:2048
    v_mfma_f32_16x16x32_bf16 v[36:39], a[80:83], a[124:127], v[36:39]
    ds_read_b128 a[124:127], v238 offset:3072
    v_mfma_f32_16x16x32_bf16 v[36:39], a[96:99], a[144:147], v[36:39]
    ds_read_b128 a[144:147], v239 offset:3072
    v_mfma_f32_16x16x32_bf16 v[40:43], a[96:99], a[148:151], v[40:43]
    ds_read_b128 a[148:151], v239 offset:4096
    v_mfma_f32_16x16x32_bf16 v[40:43], a[80:83], a[128:131], v[40:43]
    ds_read_b128 a[128:131], v238 offset:4096
    s_waitcnt lgkmcnt(8)
    v_mfma_f32_16x16x32_bf16 v[44:47], a[84:87], a[112:115], v[44:47]
    v_mfma_f32_16x16x32_bf16 v[44:47], a[100:103], a[132:135], v[44:47]
    ds_read_b64_tr_b16 a[92:93], v247 offset:0
    s_waitcnt lgkmcnt(7)
    v_mfma_f32_16x16x32_bf16 v[48:51], a[100:103], a[136:139], v[48:51]
    v_mfma_f32_16x16x32_bf16 v[48:51], a[84:87], a[116:119], v[48:51]
    ds_read_b64_tr_b16 a[94:95], v247 offset:4096
    s_waitcnt lgkmcnt(6)
    v_mfma_f32_16x16x32_bf16 v[52:55], a[84:87], a[120:123], v[52:55]
    v_mfma_f32_16x16x32_bf16 v[52:55], a[100:103], a[140:143], v[52:55]
    ds_read_b64_tr_b16 a[108:109], v247 offset:8192
    s_waitcnt lgkmcnt(5)
    v_mfma_f32_16x16x32_bf16 v[56:59], a[100:103], a[144:147], v[56:59]
    v_cvt_pk_bf16_f32 v104, v44, v45
    v_cvt_pk_bf16_f32 v105, v46, v47
    v_mfma_f32_16x16x32_bf16 v[56:59], a[84:87], a[124:127], v[56:59]
    ds_read_b64_tr_b16 a[110:111], v247 offset:12288
    s_waitcnt lgkmcnt(4)
    v_mfma_f32_16x16x32_bf16 v[60:63], a[84:87], a[128:131], v[60:63]
    v_cvt_pk_bf16_f32 v106, v48, v49
    v_cvt_pk_bf16_f32 v107, v50, v51
    v_mfma_f32_16x16x32_bf16 v[60:63], a[100:103], a[148:151], v[60:63]
    ds_read_b64_tr_b16 a[80:81], v244 offset:0
    v_mfma_f32_16x16x32_bf16 v[80:83], a[104:107], a[148:151], v[80:83]
    buffer_store_dwordx4 v[104:107], v20, s[20:23], s82 offen offset:0 sc0 sc1
    v_mfma_f32_16x16x32_bf16 v[80:83], a[88:91], a[128:131], v[80:83]
    ds_read_b64_tr_b16 a[82:83], v244 offset:4096
    v_cvt_pk_bf16_f32 v108, v52, v53
    v_mfma_f32_16x16x32_bf16 v[76:79], a[88:91], a[124:127], v[76:79]
    v_cvt_pk_bf16_f32 v109, v54, v55
    v_cvt_pk_bf16_f32 v110, v56, v57
    v_cvt_pk_bf16_f32 v111, v58, v59
    v_mfma_f32_16x16x32_bf16 v[76:79], a[104:107], a[144:147], v[76:79]
    ds_read_b64_tr_b16 a[96:97], v244 offset:8192
    v_mfma_f32_16x16x32_bf16 v[72:75], a[104:107], a[140:143], v[72:75]
    buffer_store_dwordx4 v[108:111], v20, s[20:23], s82 offen offset:1024 sc0 sc1
    v_mfma_f32_16x16x32_bf16 v[72:75], a[88:91], a[120:123], v[72:75]
    ds_read_b64_tr_b16 a[98:99], v244 offset:12288
    v_cvt_pk_bf16_f32 v112, v60, v61
    v_mfma_f32_16x16x32_bf16 v[68:71], a[88:91], a[116:119], v[68:71]
    v_cvt_pk_bf16_f32 v113, v62, v63
    v_mfma_f32_16x16x32_bf16 v[68:71], a[104:107], a[136:139], v[68:71]
    v_mfma_f32_16x16x32_bf16 v[64:67], a[104:107], a[132:135], v[64:67]
    buffer_store_dwordx2 v[112:113], v5, s[20:23], s82 offen offset:2048 sc0 sc1
    v_mfma_f32_16x16x32_bf16 v[64:67], a[88:91], a[112:115], v[64:67]
    s_waitcnt lgkmcnt(6)
    v_mfma_f32_16x16x32_bf16 v[84:87], a[92:95], a[112:115], v[84:87]
    v_cvt_pk_bf16_f32 v124, v80, v81
    v_cvt_pk_bf16_f32 v125, v82, v83
    s_waitcnt lgkmcnt(4)
    v_mfma_f32_16x16x32_bf16 v[84:87], a[108:111], a[132:135], v[84:87]
    v_cvt_pk_bf16_f32 v122, v76, v77
    v_cvt_pk_bf16_f32 v123, v78, v79
    v_mfma_f32_16x16x32_bf16 v[88:91], a[108:111], a[136:139], v[88:91]
    buffer_store_dwordx2 v[124:125], v5, s[20:23], s83 offen offset:2048 sc0 sc1
    v_mfma_f32_16x16x32_bf16 v[88:91], a[92:95], a[116:119], v[88:91]
    v_cvt_pk_bf16_f32 v120, v72, v73
    v_cvt_pk_bf16_f32 v121, v74, v75
    v_mfma_f32_16x16x32_bf16 v[92:95], a[92:95], a[120:123], v[92:95]
    buffer_store_dwordx4 v[120:123], v20, s[20:23], s83 offen offset:1024 sc0 sc1
    v_mfma_f32_16x16x32_bf16 v[92:95], a[108:111], a[140:143], v[92:95]
    v_cvt_pk_bf16_f32 v118, v68, v69
    v_cvt_pk_bf16_f32 v119, v70, v71
    v_mfma_f32_16x16x32_bf16 v[96:99], a[108:111], a[144:147], v[96:99]
    v_cvt_pk_bf16_f32 v116, v64, v65
    v_cvt_pk_bf16_f32 v117, v66, v67
    v_mfma_f32_16x16x32_bf16 v[96:99], a[92:95], a[124:127], v[96:99]
    buffer_store_dwordx4 v[116:119], v20, s[20:23], s83 offen offset:0 sc0 sc1
    v_mfma_f32_16x16x32_bf16 v[100:103], a[92:95], a[128:131], v[100:103]
    v_cvt_pk_bf16_f32 v128, v84, v85
    v_cvt_pk_bf16_f32 v129, v86, v87
    v_mfma_f32_16x16x32_bf16 v[100:103], a[108:111], a[148:151], v[100:103]
    v_cvt_pk_bf16_f32 v130, v88, v89
    v_cvt_pk_bf16_f32 v131, v90, v91
    s_waitcnt lgkmcnt(0)
    v_mfma_f32_16x16x32_bf16 v[24:27], a[96:99], a[132:135], v[24:27]
    buffer_store_dwordx4 v[128:131], v20, s[20:23], s84 offen offset:0 sc0 sc1
    v_mfma_f32_16x16x32_bf16 v[24:27], a[80:83], a[112:115], v[24:27]
    v_cvt_pk_bf16_f32 v132, v92, v93
    v_cvt_pk_bf16_f32 v133, v94, v95
    v_mfma_f32_16x16x32_bf16 v[28:31], a[80:83], a[116:119], v[28:31]
    v_cvt_pk_bf16_f32 v134, v96, v97
    v_cvt_pk_bf16_f32 v135, v98, v99
    v_mfma_f32_16x16x32_bf16 v[28:31], a[96:99], a[136:139], v[28:31]
    buffer_store_dwordx4 v[132:135], v20, s[20:23], s84 offen offset:1024 sc0 sc1
    v_mfma_f32_16x16x32_bf16 v[32:35], a[96:99], a[140:143], v[32:35]
    v_cvt_pk_bf16_f32 v136, v100, v101
    v_cvt_pk_bf16_f32 v137, v102, v103
    v_mfma_f32_16x16x32_bf16 v[32:35], a[80:83], a[120:123], v[32:35]
    buffer_store_dwordx2 v[136:137], v5, s[20:23], s84 offen offset:2048 sc0 sc1
    v_mfma_f32_16x16x32_bf16 v[36:39], a[80:83], a[124:127], v[36:39]
    v_mfma_f32_16x16x32_bf16 v[36:39], a[96:99], a[144:147], v[36:39]
    v_mfma_f32_16x16x32_bf16 v[40:43], a[96:99], a[148:151], v[40:43]
    v_mfma_f32_16x16x32_bf16 v[40:43], a[80:83], a[128:131], v[40:43]
    s_waitcnt vmcnt(0)
    s_barrier
    s_cmp_lg_u32 s28, 0
    s_cbranch_scc1 L_wait2
    s_mov_b64 exec, 1
    buffer_store_dwordx2 v[18:19], v240, s[20:23], s41 offen sc0 sc1
    s_mov_b64 exec, -1
L_wait2:
    s_mov_b32 s54, 0
L_poll3:
    buffer_load_dwordx2 v[6:7], v4, s[20:23], s91 offen sc0 sc1
    s_waitcnt vmcnt(0)
    v_cmp_ne_u64 vcc, s[64:65], v[6:7]
    s_cbranch_vccz L_wait2back
    s_sleep 4
    s_add_u32 s54, s54, 1
    s_cmp_lt_u32 s54, 100000
    s_cbranch_scc1 L_poll3
L_wait2back:
    s_mov_b32 s54, 0
L_poll2:
    buffer_load_dwordx4 v[144:147], v20, s[20:23], s85 offen offset:0 sc0 sc1
    buffer_load_dwordx4 v[156:159], v20, s[20:23], s86 offen offset:0 sc0 sc1
    buffer_load_dwordx4 v[168:171], v20, s[20:23], s87 offen offset:0 sc0 sc1
    buffer_load_dwordx4 v[148:151], v20, s[20:23], s85 offen offset:1024 sc0 sc1
    buffer_load_dwordx4 v[160:163], v20, s[20:23], s86 offen offset:1024 sc0 sc1
    buffer_load_dwordx4 v[172:175], v20, s[20:23], s87 offen offset:1024 sc0 sc1
    buffer_load_dwordx2 v[152:153], v5, s[20:23], s85 offen offset:2048 sc0 sc1
    buffer_load_dwordx2 v[164:165], v5, s[20:23], s86 offen offset:2048 sc0 sc1
    buffer_load_dwordx2 v[176:177], v5, s[20:23], s87 offen offset:2048 sc0 sc1
    s_waitcnt vmcnt(8)
    v_lshlrev_b32 v44, 16, v144
    v_and_b32 v45, 0xffff0000, v144
    v_lshlrev_b32 v46, 16, v145
    v_and_b32 v47, 0xffff0000, v145
    s_waitcnt vmcnt(7)
    v_lshlrev_b32 v64, 16, v156
    v_and_b32 v65, 0xffff0000, v156
    v_lshlrev_b32 v66, 16, v157
    v_and_b32 v67, 0xffff0000, v157
    s_waitcnt vmcnt(6)
    v_lshlrev_b32 v84, 16, v168
    v_and_b32 v85, 0xffff0000, v168
    v_lshlrev_b32 v86, 16, v169
    v_and_b32 v87, 0xffff0000, v169
    v_pk_add_f32 v[24:25], v[24:25], v[44:45]
    v_pk_add_f32 v[26:27], v[26:27], v[46:47]
    v_pk_add_f32 v[64:65], v[64:65], v[84:85]
    v_pk_add_f32 v[66:67], v[66:67], v[86:87]
    v_pk_add_f32 v[24:25], v[24:25], v[64:65]
    v_pk_add_f32 v[26:27], v[26:27], v[66:67]
    v_cvt_pk_bf16_f32 v24, v24, v25
    v_cvt_pk_bf16_f32 v25, v26, v27
    buffer_store_dwordx2 v[24:25], v255, s[68:71], s89 offen
    s_add_u32 s89, s89, 32768
    v_lshlrev_b32 v48, 16, v146
    v_and_b32 v49, 0xffff0000, v146
    v_lshlrev_b32 v50, 16, v147
    v_and_b32 v51, 0xffff0000, v147
    v_lshlrev_b32 v68, 16, v158
    v_and_b32 v69, 0xffff0000, v158
    v_lshlrev_b32 v70, 16, v159
    v_and_b32 v71, 0xffff0000, v159
    v_lshlrev_b32 v88, 16, v170
    v_and_b32 v89, 0xffff0000, v170
    v_lshlrev_b32 v90, 16, v171
    v_and_b32 v91, 0xffff0000, v171
    v_pk_add_f32 v[28:29], v[28:29], v[48:49]
    v_pk_add_f32 v[30:31], v[30:31], v[50:51]
    v_pk_add_f32 v[68:69], v[68:69], v[88:89]
    v_pk_add_f32 v[70:71], v[70:71], v[90:91]
    v_pk_add_f32 v[28:29], v[28:29], v[68:69]
    v_pk_add_f32 v[30:31], v[30:31], v[70:71]
    v_cvt_pk_bf16_f32 v28, v28, v29
    v_cvt_pk_bf16_f32 v29, v30, v31
    buffer_store_dwordx2 v[28:29], v255, s[68:71], s89 offen
    s_add_u32 s89, s89, 32768
    s_waitcnt vmcnt(7)
    v_lshlrev_b32 v52, 16, v148
    v_and_b32 v53, 0xffff0000, v148
    v_lshlrev_b32 v54, 16, v149
    v_and_b32 v55, 0xffff0000, v149
    s_waitcnt vmcnt(6)
    v_lshlrev_b32 v72, 16, v160
    v_and_b32 v73, 0xffff0000, v160
    v_lshlrev_b32 v74, 16, v161
    v_and_b32 v75, 0xffff0000, v161
    s_waitcnt vmcnt(5)
    v_lshlrev_b32 v92, 16, v172
    v_and_b32 v93, 0xffff0000, v172
    v_lshlrev_b32 v94, 16, v173
    v_and_b32 v95, 0xffff0000, v173
    v_pk_add_f32 v[32:33], v[32:33], v[52:53]
    v_pk_add_f32 v[34:35], v[34:35], v[54:55]
    v_pk_add_f32 v[72:73], v[72:73], v[92:93]
    v_pk_add_f32 v[74:75], v[74:75], v[94:95]
    v_pk_add_f32 v[32:33], v[32:33], v[72:73]
    v_pk_add_f32 v[34:35], v[34:35], v[74:75]
    v_cvt_pk_bf16_f32 v32, v32, v33
    v_cvt_pk_bf16_f32 v33, v34, v35
    buffer_store_dwordx2 v[32:33], v255, s[68:71], s89 offen
    s_add_u32 s89, s89, 32768
    v_lshlrev_b32 v56, 16, v150
    v_and_b32 v57, 0xffff0000, v150
    v_lshlrev_b32 v58, 16, v151
    v_and_b32 v59, 0xffff0000, v151
    v_lshlrev_b32 v76, 16, v162
    v_and_b32 v77, 0xffff0000, v162
    v_lshlrev_b32 v78, 16, v163
    v_and_b32 v79, 0xffff0000, v163
    v_lshlrev_b32 v96, 16, v174
    v_and_b32 v97, 0xffff0000, v174
    v_lshlrev_b32 v98, 16, v175
    v_and_b32 v99, 0xffff0000, v175
    v_pk_add_f32 v[36:37], v[36:37], v[56:57]
    v_pk_add_f32 v[38:39], v[38:39], v[58:59]
    v_pk_add_f32 v[76:77], v[76:77], v[96:97]
    v_pk_add_f32 v[78:79], v[78:79], v[98:99]
    v_pk_add_f32 v[36:37], v[36:37], v[76:77]
    v_pk_add_f32 v[38:39], v[38:39], v[78:79]
    v_cvt_pk_bf16_f32 v36, v36, v37
    v_cvt_pk_bf16_f32 v37, v38, v39
    buffer_store_dwordx2 v[36:37], v255, s[68:71], s89 offen
    s_add_u32 s89, s89, 32768
    s_waitcnt vmcnt(6)
    v_lshlrev_b32 v60, 16, v152
    v_and_b32 v61, 0xffff0000, v152
    v_lshlrev_b32 v62, 16, v153
    v_and_b32 v63, 0xffff0000, v153
    s_waitcnt vmcnt(5)
    v_lshlrev_b32 v80, 16, v164
    v_and_b32 v81, 0xffff0000, v164
    v_lshlrev_b32 v82, 16, v165
    v_and_b32 v83, 0xffff0000, v165
    s_waitcnt vmcnt(4)
    v_lshlrev_b32 v100, 16, v176
    v_and_b32 v101, 0xffff0000, v176
    v_lshlrev_b32 v102, 16, v177
    v_and_b32 v103, 0xffff0000, v177
    v_pk_add_f32 v[40:41], v[40:41], v[60:61]
    v_pk_add_f32 v[42:43], v[42:43], v[62:63]
    v_pk_add_f32 v[80:81], v[80:81], v[100:101]
    v_pk_add_f32 v[82:83], v[82:83], v[102:103]
    v_pk_add_f32 v[40:41], v[40:41], v[80:81]
    v_pk_add_f32 v[42:43], v[42:43], v[82:83]
    v_cvt_pk_bf16_f32 v40, v40, v41
    v_cvt_pk_bf16_f32 v41, v42, v43
    buffer_store_dwordx2 v[40:41], v255, s[68:71], s89 offen
L_end:
    s_endpgm
L_xtra:
    s_add_u32 m0, m0, 4096
    s_cmp_eq_u32 m0, s63
    s_cselect_b32 m0, s45, m0
    s_add_u32 s48, s48, 4096
    buffer_load_dwordx4 v17, s[12:15], s55 offen nt lds
    s_add_u32 m0, m0, 4096
    s_nop 0
    buffer_load_dwordx4 v17, s[16:19], s55 offen nt lds
    s_xor_b32 s55, s48, s66
    s_branch L_xtraback
L_wait1:
    s_mov_b32 s54, 0
L_poll1:
    buffer_load_dwordx2 v[22:23], v21, s[20:23], s88 offen offset:2048 sc1
    s_waitcnt vmcnt(0)
    v_cmp_eq_u64 s[92:93], s[64:65], v[22:23]
    s_nop 0
    s_or_b32 s90, s90, s92
    s_bitcmp1_b32 s90, s43
    s_cbranch_scc1 L_wait1back
    s_sleep 2
    buffer_load_dwordx2 v[22:23], v21, s[20:23], s88 offen offset:2048 sc1
    s_waitcnt vmcnt(0)
    v_cmp_eq_u64 s[92:93], s[64:65], v[22:23]
    s_nop 0
    s_or_b32 s90, s90, s92
    s_bitcmp1_b32 s90, s43
    s_cbranch_scc1 L_wait1back
    s_sleep 2
    buffer_load_dwordx2 v[22:23], v21, s[20:23], s88 offen offset:2048 sc1
    s_waitcnt vmcnt(0)
    v_cmp_eq_u64 s[92:93], s[64:65], v[22:23]
    s_nop 0
    s_or_b32 s90, s90, s92
    s_bitcmp1_b32 s90, s43
    s_cbranch_scc1 L_wait1back
    s_sleep 2
    buffer_load_dwordx2 v[22:23], v21, s[20:23], s88 offen offset:2048 sc1
    s_waitcnt vmcnt(0)
    v_cmp_eq_u64 s[92:93], s[64:65], v[22:23]
    s_nop 0
    s_or_b32 s90, s90, s92
    s_bitcmp1_b32 s90, s43
    s_cbranch_scc1 L_wait1back
    s_sleep 2
    buffer_load_dwordx2 v[22:23], v21, s[20:23], s88 offen offset:2048 sc1
    s_waitcnt vmcnt(0)
    v_cmp_eq_u64 s[92:93], s[64:65], v[22:23]
    s_nop 0
    s_or_b32 s90, s90, s92
    s_bitcmp1_b32 s90, s43
    s_cbranch_scc1 L_wait1back
    s_sleep 2
    buffer_load_dwordx2 v[22:23], v21, s[20:23], s88 offen offset:2048 sc1
    s_waitcnt vmcnt(0)
    v_cmp_eq_u64 s[92:93], s[64:65], v[22:23]
    s_nop 0
    s_or_b32 s90, s90, s92
    s_bitcmp1_b32 s90, s43
    s_cbranch_scc1 L_wait1back
    s_sleep 2
    buffer_load_dwordx2 v[22:23], v21, s[20:23], s88 offen sc0 sc1
    s_waitcnt vmcnt(0)
    v_cmp_eq_u64 s[92:93], s[64:65], v[22:23]
    s_nop 0
    s_or_b32 s90, s90, s92
    s_bitcmp1_b32 s90, s43
    s_cbranch_scc1 L_wait1back
    s_add_u32 s54, s54, 1
    s_cmp_lt_u32 s54, 100000
    s_cbranch_scc1 L_poll1
    s_branch L_wait1back
L_aux:
    s_cmp_lg_u32 s63, 0
    s_cbranch_scc1 L_aux1
    s_mov_b32 m0, s47
    s_add_u32 s47, s47, 8192
    buffer_load_dwordx4 v17, s[12:15], s55 offen nt lds
    s_add_u32 m0, m0, 4096
    s_add_u32 s48, s48, 4096
    buffer_load_dwordx4 v17, s[16:19], s55 offen nt lds
    s_xor_b32 s55, s48, s66
    s_mov_b32 m0, s47
    s_add_u32 s47, s47, 8192
    buffer_load_dwordx4 v17, s[12:15], s55 offen nt lds
    s_add_u32 m0, m0, 4096
    s_add_u32 s48, s48, 4096
    buffer_load_dwordx4 v17, s[16:19], s55 offen nt lds
    s_xor_b32 s55, s48, s66
    s_add_u32 s63, s63, 1
    v_mov_b32 v240, 0
    v_mov_b32 v241, 0
    v_mov_b32 v242, 0
    v_mov_b32 v243, 0
    v_lshlrev_b32 v20, 4, v1
    v_add_u32 v236, 4096, v20
    v_lshrrev_b32 v21, 4, v1
    v_and_b32 v22, 7, v1
    v_lshlrev_b32 v22, 1, v22
    v_xor_b32 v22, v22, v21
    v_lshlrev_b32 v22, 4, v22
    v_and_b32 v23, 15, v1
    v_lshlrev_b32 v23, 8, v23
    v_mfma_f32_32x32x16_bf16 v[104:119], v[240:243], v[240:243], 0
    v_add_u32 v22, v22, v23
    s_lshl_b32 s41, s57, 14
    v_xor_b32 v184, 0, v22
    v_add_u32 v184, s41, v184
    v_xor_b32 v185, 64, v22
    v_add_u32 v185, s41, v185
    v_xor_b32 v186, 128, v22
    v_mfma_f32_32x32x16_bf16 v[120:135], v[240:243], v[240:243], 0
    v_add_u32 v186, s41, v186
    v_xor_b32 v187, 192, v22
    v_add_u32 v187, s41, v187
    v_lshrrev_b32 v21, 2, v1
    v_and_b32 v22, 7, v21
    s_lshl_b32 s42, s57, 2
    v_xor_b32 v22, s42, v22
    v_mfma_f32_32x32x16_bf16 v[136:151], v[240:243], v[240:243], 0
    v_lshlrev_b32 v22, 5, v22
    v_lshlrev_b32 v21, 8, v21
    v_and_b32 v23, 3, v1
    v_lshlrev_b32 v23, 3, v23
    v_add3_u32 v22, v22, v21, v23
    s_add_u32 s41, s41, 4096
    v_xor_b32 v188, 0, v22
    v_mfma_f32_32x32x16_bf16 v[152:167], v[240:243], v[240:243], 0
    v_add_u32 v188, s41, v188
    v_xor_b32 v189, 32, v22
    v_add_u32 v189, s41, v189
    v_xor_b32 v190, 64, v22
    v_add_u32 v190, s41, v190
    v_xor_b32 v191, 96, v22
    v_add_u32 v191, s41, v191
    v_mfma_f32_32x32x16_bf16 v[168:183], v[240:243], v[240:243], 0
    v_xor_b32 v192, 128, v22
    v_add_u32 v192, s41, v192
    v_xor_b32 v193, 160, v22
    v_add_u32 v193, s41, v193
    v_xor_b32 v194, 192, v22
    v_add_u32 v194, s41, v194
    v_xor_b32 v195, 224, v22
    v_mfma_f32_32x32x16_bf16 a[0:15], v[240:243], v[240:243], 0
    v_add_u32 v195, s41, v195
    s_mov_b32 s46, 0
    v_mov_b32 v21, 0x3f803f80
    v_and_b32 v22, 15, v1
    v_cmp_eq_u32 s[92:93], 0, v22
    s_nop 1
    v_cndmask_b32 v21, 0, v21, s[92:93]
    v_accvgpr_write_b32 a224, v21
    v_accvgpr_write_b32 a225, v21
    v_accvgpr_write_b32 a226, v21
    v_accvgpr_write_b32 a227, v21
    s_mov_b32 s49, 0
    s_mov_b32 s53, 0x3e0293ee
    s_waitcnt vmcnt(13) lgkmcnt(0)
    s_branch L_auxback
L_aux1:
    s_cmp_lg_u32 s63, 1
    s_cbranch_scc1 L_aux2
    s_mov_b32 m0, s47
    s_add_u32 s47, s47, 8192
    buffer_load_dwordx4 v17, s[12:15], s55 offen nt lds
    s_add_u32 m0, m0, 4096
    s_add_u32 s48, s48, 4096
    buffer_load_dwordx4 v17, s[16:19], s55 offen nt lds
    s_xor_b32 s55, s48, s66
    s_mov_b32 m0, s47
    s_add_u32 s47, s47, 8192
    buffer_load_dwordx4 v17, s[12:15], s55 offen nt lds
    s_add_u32 m0, m0, 4096
    s_add_u32 s48, s48, 4096
    buffer_load_dwordx4 v17, s[16:19], s55 offen nt lds
    s_xor_b32 s55, s48, s66
    s_mov_b32 m0, s47
    s_add_u32 s47, s47, 8192
    buffer_load_dwordx4 v17, s[12:15], s55 offen nt lds
    s_add_u32 m0, m0, 4096
    s_add_u32 s48, s48, 4096
    buffer_load_dwordx4 v17, s[16:19], s55 offen nt lds
    s_xor_b32 s55, s48, s66
    s_add_u32 s63, s63, 1
    v_lshrrev_b32 v21, 4, v1
    v_lshlrev_b32 v22, 1, v21
    v_and_b32 v23, 15, v1
    v_xor_b32 v22, v22, v23
    v_lshlrev_b32 v22, 4, v22
    v_lshlrev_b32 v23, 11, v23
    v_lshlrev_b32 v255, 3, v21
    v_add_u32 v255, v255, v23
    v_lshlrev_b32 v23, 11, v21
    v_add_u32 v23, v23, v22
    v_mfma_f32_32x32x16_bf16 a[16:31], v[240:243], v[240:243], 0
    v_xor_b32 v22, 128, v23
    s_lshl_b32 s41, s28, 15
    s_add_u32 s42, s41, 0
    v_add_u32 v248, s42, v23
    s_add_u32 s42, s41, 7168
    v_add_u32 v249, s42, v22
    s_add_u32 s42, s41, 14336
    v_add_u32 v250, s42, v23
    s_add_u32 s42, s41, 21504
    v_add_u32 v251, s42, v22
    v_mfma_f32_32x32x16_bf16 a[32:47], v[240:243], v[240:243], 0
    v_add_u32 v252, s44, v20
    v_add_u32 v253, s40, v20
    s_mul_i32 s41, s56, 5120
    s_add_u32 s41, s41, 90112
    v_add_u32 v238, s41, v20
    v_add_u32 v239, 10240, v238
    v_lshrrev_b32 v21, 2, v1
    v_and_b32 v22, 7, v21
    s_lshl_b32 s41, s62, 1
    s_add_u32 s41, s41, s57
    v_mfma_f32_32x32x16_bf16 a[48:63], v[240:243], v[240:243], 0
    v_xor_b32 v22, s41, v22
    v_lshlrev_b32 v22, 5, v22
    v_lshlrev_b32 v21, 8, v21
    v_and_b32 v23, 3, v1
    v_lshlrev_b32 v23, 3, v23
    v_add3_u32 v22, v22, v21, v23
    v_xor_b32 v244, 0, v22
    v_add_u32 v244, 110592, v244
    v_xor_b32 v245, 64, v22
    v_add_u32 v245, 110592, v245
    v_mfma_f32_32x32x16_bf16 a[64:79], v[240:243], v[240:243], 0
    v_xor_b32 v246, 128, v22
    v_add_u32 v246, 110592, v246
    v_xor_b32 v247, 192, v22
    v_add_u32 v247, 110592, v247
    s_lshl_b32 s89, s41, 5
    s_mul_i32 s42, s56, 163840
    s_add_u32 s89, s89, s42
    s_lshl_b32 s43, s61, 8
    s_add_u32 s89, s89, s43
    s_mov_b32 s80, 2557891634
    v_mfma_f32_32x32x16_bf16 v[216:231], v[240:243], v[240:243], 0
    s_mov_b32 s81, 16632810
    s_cmp_eq_u32 s60, 1
    s_cselect_b32 s80, 2556904739, s80
    s_cselect_b32 s81, 15585195, s81
    s_cmp_eq_u32 s60, 2
    s_cselect_b32 s80, 2540188244, s80
    s_cselect_b32 s81, 16702380, s81
    s_cmp_eq_u32 s60, 3
    s_cselect_b32 s80, 2271814469, s80
    s_cselect_b32 s81, 16698285, s81
    v_mfma_f32_16x16x32_bf16 v[232:235], v[240:243], v[240:243], 0
    s_mul_i32 s41, s61, 0x22222222
    s_xor_b32 s80, s80, s41
    s_xor_b32 s81, s81, s41
    s_and_b32 s41, s80, 15
    s_lshl_b32 s41, s41, 17
    s_lshl_b32 s42, s28, 15
    s_add_u32 s41, s41, s42
    v_lshrrev_b32 v21, 1, v1
    v_lshlrev_b32 v21, 11, v21
    v_and_b32 v22, 1, v1
    v_lshlrev_b32 v22, 7, v22
    v_add3_u32 v21, v21, v22, s41
    v_lshrrev_b32 v22, 5, v1
    v_lshlrev_b32 v22, 30, v22
    v_add_u32 v237, v21, v22
    s_waitcnt vmcnt(15) lgkmcnt(0)
    s_branch L_auxback
L_aux2:
    s_mov_b32 m0, s47
    s_add_u32 s47, s47, 8192
    buffer_load_dwordx4 v17, s[12:15], s55 offen nt lds
    s_add_u32 m0, m0, 4096
    s_add_u32 s48, s48, 4096
    buffer_load_dwordx4 v17, s[16:19], s55 offen nt lds
    s_xor_b32 s55, s48, s66
    s_xor_b32 s41, s66, 61440
    buffer_load_dwordx4 a[192:195], v17, s[12:15], s41 offen nt
    buffer_load_dwordx4 a[196:199], v17, s[16:19], s41 offen nt
    s_xor_b32 s41, s66, 65536
    buffer_load_dwordx4 a[200:203], v17, s[12:15], s41 offen nt
    buffer_load_dwordx4 a[204:207], v17, s[16:19], s41 offen nt
    s_add_u32 s63, s63, 1
    s_mul_i32 s41, s29, 1310720
    s_lshl_b32 s42, s30, 1
    s_add_u32 s42, s42, s57
    s_mul_i32 s42, s42, 20480
    s_add_u32 s50, s41, s42
    s_mul_i32 s42, s56, 5120
    s_add_u32 s50, s50, s42
    s_add_u32 s51, s50, 10240
    s_lshl_b32 s41, s29, 2
    s_add_u32 s41, s41, s62
    s_mul_i32 s41, s41, 8448
    s_add_u32 s88, s41, 25165824
    s_lshl_b32 s41, s29, 3
    s_add_u32 s41, s41, s61
    s_lshl_b32 s91, s41, 2
    s_mul_i32 s91, s91, 4352
    s_add_u32 s91, s91, 26214400
    s_mul_i32 s41, s41, 163840
    s_mul_i32 s42, s28, 2560
    s_add_u32 s41, s41, s42
    s_add_u32 s41, s41, 12582912
    s_xor_b32 s42, s62, 1
    s_lshl_b32 s43, s42, 2
    s_add_u32 s43, s43, s62
    s_mul_i32 s43, s43, 10240
    s_add_u32 s82, s41, s43
    s_lshl_b32 s43, s62, 2
    s_add_u32 s43, s43, s42
    s_mul_i32 s43, s43, 10240
    s_add_u32 s85, s41, s43
    s_xor_b32 s42, s62, 2
    s_lshl_b32 s43, s42, 2
    s_add_u32 s43, s43, s62
    s_mul_i32 s43, s43, 10240
    s_add_u32 s83, s41, s43
    s_lshl_b32 s43, s62, 2
    s_add_u32 s43, s43, s42
    s_mul_i32 s43, s43, 10240
    s_add_u32 s86, s41, s43
    s_xor_b32 s42, s62, 3
    s_lshl_b32 s43, s42, 2
    s_add_u32 s43, s43, s62
    s_mul_i32 s43, s43, 10240
    s_add_u32 s84, s41, s43
    s_lshl_b32 s43, s62, 2
    s_add_u32 s43, s43, s42
    s_mul_i32 s43, s43, 10240
    s_add_u32 s87, s41, s43
    v_lshrrev_b32 v21, 5, v1
    v_lshlrev_b32 v21, 8, v21
    v_and_b32 v22, 15, v1
    v_lshlrev_b32 v22, 4, v22
    v_lshrrev_b32 v23, 1, v1
    v_and_b32 v23, 8, v23
    v_add3_u32 v21, v21, v22, v23
    s_mul_i32 s42, s56, 20480
    s_add_u32 s42, s42, 122880
    v_add_u32 v22, s42, v20
    s_lshl_b32 s43, s57, 11
    s_add_u32 s42, s42, s43
    v_add_u32 v21, s42, v21
    v_and_b32 v23, 48, v1
    s_waitcnt vmcnt(15) lgkmcnt(0)
    s_branch L_auxback
L_slow:
    s_waitcnt vmcnt(0) lgkmcnt(0)
    s_barrier
    s_mov_b32 s49, 1
    v_and_b32 v21, 15, v1
    v_lshlrev_b32 v21, 8, v21
    v_lshrrev_b32 v22, 4, v1
    v_lshlrev_b32 v22, 4, v22
    v_add_u32 v21, v21, v22
    v_mov_b32 v72, 0xff800000
    v_mov_b32 v73, 0xff800000
    v_mov_b32 v74, 0xff800000
    v_mov_b32 v75, 0xff800000
    v_mov_b32 v76, 0xff800000
    s_mov_b32 s31, 0
L_slowloop:
    buffer_load_dwordx4 v[24:27], v21, s[12:15], s31 offen offset:0
    buffer_load_dwordx4 v[28:31], v21, s[12:15], s31 offen offset:64
    buffer_load_dwordx4 v[32:35], v21, s[12:15], s31 offen offset:128
    buffer_load_dwordx4 v[36:39], v21, s[12:15], s31 offen offset:192
    s_waitcnt vmcnt(0)
    v_mfma_f32_16x16x32_bf16 v[80:83], v[24:27], a[80:83], 0
    v_mfma_f32_16x16x32_bf16 v[80:83], v[28:31], a[84:87], v[80:83]
    v_mfma_f32_16x16x32_bf16 v[80:83], v[32:35], a[88:91], v[80:83]
    v_mfma_f32_16x16x32_bf16 v[80:83], v[36:39], a[92:95], v[80:83]
    v_mfma_f32_16x16x32_bf16 v[84:87], v[24:27], a[96:99], 0
    v_mfma_f32_16x16x32_bf16 v[84:87], v[28:31], a[100:103], v[84:87]
    v_mfma_f32_16x16x32_bf16 v[84:87], v[32:35], a[104:107], v[84:87]
    v_mfma_f32_16x16x32_bf16 v[84:87], v[36:39], a[108:111], v[84:87]
    v_mfma_f32_16x16x32_bf16 v[88:91], v[24:27], a[112:115], 0
    v_mfma_f32_16x16x32_bf16 v[88:91], v[28:31], a[116:119], v[88:91]
    v_mfma_f32_16x16x32_bf16 v[88:91], v[32:35], a[120:123], v[88:91]
    v_mfma_f32_16x16x32_bf16 v[88:91], v[36:39], a[124:127], v[88:91]
    v_mfma_f32_16x16x32_bf16 v[92:95], v[24:27], a[128:131], 0
    v_mfma_f32_16x16x32_bf16 v[92:95], v[28:31], a[132:135], v[92:95]
    v_mfma_f32_16x16x32_bf16 v[92:95], v[32:35], a[136:139], v[92:95]
    v_mfma_f32_16x16x32_bf16 v[92:95], v[36:39], a[140:143], v[92:95]
    v_mfma_f32_16x16x32_bf16 v[96:99], v[24:27], a[144:147], 0
    v_mfma_f32_16x16x32_bf16 v[96:99], v[28:31], a[148:151], v[96:99]
    v_mfma_f32_16x16x32_bf16 v[96:99], v[32:35], a[152:155], v[96:99]
    v_mfma_f32_16x16x32_bf16 v[96:99], v[36:39], a[156:159], v[96:99]
    v_max3_f32 v72, v72, v80, v81
    v_max3_f32 v72, v72, v82, v83
    v_max3_f32 v73, v73, v84, v85
    v_max3_f32 v73, v73, v86, v87
    v_max3_f32 v74, v74, v88, v89
    v_max3_f32 v74, v74, v90, v91
    v_max3_f32 v75, v75, v92, v93
    v_max3_f32 v75, v75, v94, v95
    v_max3_f32 v76, v76, v96, v97
    v_max3_f32 v76, v76, v98, v99
    s_add_u32 s31, s31, 4096
    s_cmp_lt_u32 s31, 131072
    s_cbranch_scc1 L_slowloop
    v_mov_b32 v64, v72
    v_mov_b32 v65, v73
    v_mov_b32 v66, v74
    v_mov_b32 v67, v75
    v_mov_b32 v68, v76
    v_permlane16_swap_b32 v72, v64
    v_permlane16_swap_b32 v73, v65
    v_permlane16_swap_b32 v74, v66
    v_permlane16_swap_b32 v75, v67
    v_permlane16_swap_b32 v76, v68
    v_max_f32 v72, v72, v64
    v_max_f32 v73, v73, v65
    v_max_f32 v74, v74, v66
    v_max_f32 v75, v75, v67
    v_max_f32 v76, v76, v68
    v_mov_b32 v64, v72
    v_mov_b32 v65, v73
    v_mov_b32 v66, v74
    v_mov_b32 v67, v75
    v_mov_b32 v68, v76
    v_permlane32_swap_b32 v72, v64
    v_permlane32_swap_b32 v73, v65
    v_permlane32_swap_b32 v74, v66
    v_permlane32_swap_b32 v75, v67
    v_permlane32_swap_b32 v76, v68
    v_max_f32 v72, v72, v64
    v_max_f32 v73, v73, v65
    v_max_f32 v74, v74, v66
    v_max_f32 v75, v75, v67
    v_max_f32 v76, v76, v68
    v_sub_f32 v196, 0, v72
    v_sub_f32 v197, 0, v72
    v_sub_f32 v198, 0, v72
    v_sub_f32 v199, 0, v72
    v_sub_f32 v200, 0, v73
    v_sub_f32 v201, 0, v73
    v_sub_f32 v202, 0, v73
    v_sub_f32 v203, 0, v73
    v_sub_f32 v204, 0, v74
    v_sub_f32 v205, 0, v74
    v_sub_f32 v206, 0, v74
    v_sub_f32 v207, 0, v74
    v_sub_f32 v208, 0, v75
    v_sub_f32 v209, 0, v75
    v_sub_f32 v210, 0, v75
    v_sub_f32 v211, 0, v75
    v_sub_f32 v212, 0, v76
    v_sub_f32 v213, 0, v76
    v_sub_f32 v214, 0, v76
    v_sub_f32 v215, 0, v76
    v_lshrrev_b32 v21, 4, v1
    v_and_b32 v22, 7, v1
    v_lshlrev_b32 v22, 1, v22
    v_xor_b32 v22, v22, v21
    v_lshlrev_b32 v22, 4, v22
    v_and_b32 v23, 15, v1
    v_lshlrev_b32 v23, 8, v23
    v_add_u32 v22, v22, v23
    s_lshl_b32 s41, s57, 14
    v_xor_b32 v184, 0, v22
    v_add_u32 v184, s41, v184
    v_xor_b32 v185, 64, v22
    v_add_u32 v185, s41, v185
    v_xor_b32 v186, 128, v22
    v_add_u32 v186, s41, v186
    v_xor_b32 v187, 192, v22
    v_add_u32 v187, s41, v187
    v_lshrrev_b32 v21, 2, v1
    v_and_b32 v22, 7, v21
    s_lshl_b32 s42, s57, 2
    v_xor_b32 v22, s42, v22
    v_lshlrev_b32 v22, 5, v22
    v_lshlrev_b32 v21, 8, v21
    v_and_b32 v23, 3, v1
    v_lshlrev_b32 v23, 3, v23
    v_add3_u32 v22, v22, v21, v23
    s_add_u32 s41, s41, 4096
    v_xor_b32 v188, 0, v22
    v_add_u32 v188, s41, v188
    v_xor_b32 v189, 32, v22
    v_add_u32 v189, s41, v189
    v_xor_b32 v190, 64, v22
    v_add_u32 v190, s41, v190
    v_xor_b32 v191, 96, v22
    v_add_u32 v191, s41, v191
    v_xor_b32 v192, 128, v22
    v_add_u32 v192, s41, v192
    v_xor_b32 v193, 160, v22
    v_add_u32 v193, s41, v193
    v_xor_b32 v194, 192, v22
    v_add_u32 v194, s41, v194
    v_xor_b32 v195, 224, v22
    v_add_u32 v195, s41, v195
    s_mov_b32 s46, 0
    s_mov_b32 s47, s45
    s_mov_b32 s48, 0
    s_mov_b32 s55, s66
    v_mfma_f32_32x32x16_bf16 v[104:119], v[240:243], v[240:243], 0
    v_mfma_f32_32x32x16_bf16 v[120:135], v[240:243], v[240:243], 0
    v_mfma_f32_32x32x16_bf16 v[136:151], v[240:243], v[240:243], 0
    v_mfma_f32_32x32x16_bf16 v[152:167], v[240:243], v[240:243], 0
    v_mfma_f32_32x32x16_bf16 v[168:183], v[240:243], v[240:243], 0
    v_mfma_f32_32x32x16_bf16 a[0:15], v[240:243], v[240:243], 0
    v_mfma_f32_32x32x16_bf16 a[16:31], v[240:243], v[240:243], 0
    v_mfma_f32_32x32x16_bf16 a[32:47], v[240:243], v[240:243], 0
    v_mfma_f32_32x32x16_bf16 a[48:63], v[240:243], v[240:243], 0
    v_mfma_f32_32x32x16_bf16 a[64:79], v[240:243], v[240:243], 0
    v_mfma_f32_32x32x16_bf16 v[216:231], v[240:243], v[240:243], 0
    v_mfma_f32_16x16x32_bf16 v[232:235], v[240:243], v[240:243], 0
L_slowkv:
    s_mov_b32 m0, s47
    s_add_u32 s47, s47, 8192
    buffer_load_dwordx4 v17, s[12:15], s55 offen nt lds
    s_add_u32 m0, m0, 4096
    s_add_u32 s48, s48, 4096
    buffer_load_dwordx4 v17, s[16:19], s55 offen nt lds
    s_xor_b32 s55, s48, s66
    s_cmp_lt_u32 s48, 69632
    s_cbranch_scc1 L_slowkv
    s_waitcnt vmcnt(0)
    s_barrier
    ds_read_b128 a[160:163], v184 offset:0
    ds_read_b128 a[164:167], v185 offset:0
    ds_read_b128 a[168:171], v186 offset:0
    ds_read_b128 a[172:175], v187 offset:0
    ds_read_b128 a[176:179], v184 offset:8192
    ds_read_b128 a[180:183], v185 offset:8192
    ds_read_b128 a[184:187], v186 offset:8192
    ds_read_b128 a[188:191], v187 offset:8192
    ds_read_b64_tr_b16 a[192:193], v188 offset:0
    ds_read_b64_tr_b16 a[194:195], v188 offset:8192
    ds_read_b64_tr_b16 a[196:197], v189 offset:0
    ds_read_b64_tr_b16 a[198:199], v189 offset:8192
    s_waitcnt lgkmcnt(11)
    v_mfma_f32_16x16x32_bf16 v[24:27], a[160:163], a[80:83], v[196:199]
    s_waitcnt lgkmcnt(10)
    v_mfma_f32_16x16x32_bf16 v[24:27], a[164:167], a[84:87], v[24:27]
    s_waitcnt lgkmcnt(9)
    v_mfma_f32_16x16x32_bf16 v[24:27], a[168:171], a[88:91], v[24:27]
    s_waitcnt lgkmcnt(8)
    v_mfma_f32_16x16x32_bf16 v[24:27], a[172:175], a[92:95], v[24:27]
    s_waitcnt lgkmcnt(7)
    v_mfma_f32_16x16x32_bf16 v[28:31], a[176:179], a[80:83], v[196:199]
    s_waitcnt lgkmcnt(6)
    v_mfma_f32_16x16x32_bf16 v[28:31], a[180:183], a[84:87], v[28:31]
    s_waitcnt lgkmcnt(5)
    v_mfma_f32_16x16x32_bf16 v[28:31], a[184:187], a[88:91], v[28:31]
    s_waitcnt lgkmcnt(4)
    v_mfma_f32_16x16x32_bf16 v[28:31], a[188:191], a[92:95], v[28:31]
    s_nop 7
L_last:
    s_branch L_p2entry
.section .rodata,"a"
.p2align 6
.amdhsa_kernel standalone__mha_block_cached__near_ridge_kernel
  .amdhsa_next_free_vgpr 512
  .amdhsa_next_free_sgpr 102
  .amdhsa_accum_offset 256
  .amdhsa_group_segment_fixed_size 0
  .amdhsa_kernarg_size 64
  .amdhsa_user_sgpr_count 2
  .amdhsa_user_sgpr_kernarg_segment_ptr 1
  .amdhsa_system_sgpr_workgroup_id_x 1
.end_amdhsa_kernel
```
